```python
import torch

def _softmax(x, axis=-1):
    return torch.softmax(x, dim=axis)
def _gelu(x):
    return torch.nn.functional.gelu(x, approximate="tanh")
def _silu(x):
    return torch.nn.functional.silu(x)
def _sigmoid(x):
    return torch.sigmoid(x)
def _layernorm(x, axis=-1, eps=1e-5):
    m = x.mean(dim=axis, keepdim=True)
    v = x.var(dim=axis, keepdim=True, unbiased=False)
    return (x - m) / torch.sqrt(v + eps)
def _scatter_add(tgt, idx, src, axis=0):
    return tgt.clone().index_add_(axis, idx, src)
def _segment_sum(src, seg, n):
    out = torch.zeros((n,) + src.shape[1:], dtype=src.dtype)
    return out.index_add_(0, seg, src)
def _pad(x, pw):
    flat = tuple(v for pair in reversed(pw) for v in pair)
    return torch.nn.functional.pad(x, flat)

kernel_name = 'sequential_preLN__linear_attn_block__dense_activation_silu__prompt'

def setup_inputs():

    _w = (lambda a: (lambda t: t.to(torch.bfloat16) if t.is_floating_point() else t)(torch.as_tensor(a)))
    def _A_setup():
        B, S, D = 1, 2048, 512
        return {
            "x": _w((lambda *s: torch.randn(*s, dtype=torch.bfloat16) * 0.05)(B, S, D)),
            "wqkv": _w((lambda *s: torch.randn(*s, dtype=torch.bfloat16) * 0.05)(D, 3 * D)),
            "wo": _w((lambda *s: torch.randn(*s, dtype=torch.bfloat16) * 0.05)(D, D)),
        }
    _A_in = _A_setup()

    def _B_setup():
        B, S, D, F = 1, 2048, 512, 1792
        return {
            "x": _w((lambda *s: torch.randn(*s, dtype=torch.bfloat16) * 0.05)(B, S, D)),
            "w1": _w((lambda *s: torch.randn(*s, dtype=torch.bfloat16) * 0.8)(D, F) * (D ** -0.5)),
            "w2": _w((lambda *s: torch.randn(*s, dtype=torch.bfloat16) * 0.1)(F, D) * (F ** -0.5)),
        }
    _B_in = _B_setup()

    return {
        "A_x": _A_in["x"],
        "A_wqkv": _A_in["wqkv"],
        "A_wo": _A_in["wo"],
        "B_x": _B_in["x"],
        "B_w1": _B_in["w1"],
        "B_w2": _B_in["w2"],
    }

def reference(A_x, A_wqkv, A_wo, B_x, B_w1, B_w2):
    def _A_ref(x, wqkv, wo):
        B, S, D = x.shape
        H = 32; Dh = D // H
        qkv = (lambda x, *d: x.permute(*d))((x @ wqkv).reshape(B, S, 3, H, Dh), 2, 0, 3, 1, 4)
        q, k, v = qkv[0], qkv[1], qkv[2]
        phi = lambda t: torch.where(t > 0, t + 1, torch.exp(t)) + 1e-6
        pq, pk = phi(q), phi(k)
        kv = torch.einsum("bhsd,bhse->bhde", pk, v)
        z = torch.einsum("bhsd->bhd", pk)
        num = torch.einsum("bhqd,bhde->bhqe", pq, kv)
        den = torch.einsum("bhqd,bhd->bhq", pq, z)[..., None] + 1e-6
        o = num / den
        return (lambda x, *d: x.permute(*d))(o, 0, 2, 1, 3).reshape(B, S, D) @ wo

    def _B_ref(x, w1, w2):
        h = torch.einsum("bsd,df->bsf", x, w1)
        h = _silu(h)
        out = torch.einsum("bsf,fd->bsd", h, w2)
        return out

    x = A_x
    h = x + _A_ref(_layernorm(x, axis=-1), A_wqkv, A_wo)
    h2 = h + _B_ref(_layernorm(h, axis=-1), B_w1, B_w2)
    return h2
```

```asm
; @launch kernel=k1_kernel grid=(256,1,1) block=(256,1,1) lds=149504
; @launch kernel=k2_kernel grid=(256,1,1) block=(256,1,1) lds=132096
; @launch kernel=k3_kernel grid=(256,1,1) block=(512,1,1) lds=131072
; @launch kernel=k4_kernel grid=(256,1,1) block=(256,1,1) lds=65536
.amdgcn_target "amdgcn-amd-amdhsa--gfx950"
.text
.globl k1_kernel
.p2align 8
.type k1_kernel,@function
k1_kernel:
  s_cmp_ge_u32 s2, 256
  s_cbranch_scc1 k1_kernel_end
  s_load_dwordx2 s[36:37], s[0:1], 0
  s_load_dwordx2 s[38:39], s[0:1], 8
  s_load_dwordx2 s[40:41], s[0:1], 56
  s_load_dwordx2 s[42:43], s[0:1], 64
  s_and_b32 s6, s2, 7
  s_lshr_b32 s7, s6, 1
  s_lshl_b32 s3, s7, 3
  s_bfe_u32 s7, s2, 0x30003
  s_add_u32 s3, s3, s7
  s_and_b32 s7, s6, 1
  s_lshl_b32 s4, s7, 2
  s_lshr_b32 s7, s2, 6
  s_add_u32 s4, s4, s7
  v_and_b32 v1, 63, v0
  v_lshrrev_b32 v4, 6, v0
  v_lshrrev_b32 v2, 4, v1
  v_readfirstlane_b32 s5, v4
  v_and_b32 v3, 15, v1
  s_mov_b32 s30, 0x3f803f80
  s_waitcnt lgkmcnt(0)
  s_lshl_b32 s6, s3, 16
  s_lshl_b32 s7, s5, 14
  s_add_u32 s6, s6, s7
  s_add_u32 s8, s36, s6
  s_addc_u32 s9, s37, 0
  s_mov_b32 s10, 16384
  s_mov_b32 s11, 0x00020000
  s_lshl_b32 s6, s4, 7
  s_add_u32 s12, s38, s6
  s_addc_u32 s13, s39, 0
  s_sub_u32 s14, 1572864, s6
  s_mov_b32 s15, 0x00020000
  s_mov_b32 s16, s42
  s_mov_b32 s17, s43
  s_mov_b32 s18, 268435456
  s_mov_b32 s19, 0x00020000
  s_mov_b32 s20, s40
  s_mov_b32 s21, s41
  s_mov_b32 s22, 256
  s_mov_b32 s23, 0x00020000
  s_mul_i32 s6, s4, 4352
  s_add_u32 s6, s6, 2097152
  s_add_u32 s24, s42, s6
  s_addc_u32 s25, s43, 0
  s_mov_b32 s26, 4352
  s_mov_b32 s27, 0x00020000
  v_lshlrev_b32 v10, 10, v3
  v_lshl_add_u32 v10, v2, 4, v10
  buffer_load_dwordx4 v[164:167], v10, s[8:11], 0 offen offset:0
  buffer_load_dwordx4 v[168:171], v10, s[8:11], 0 offen offset:64
  buffer_load_dwordx4 v[172:175], v10, s[8:11], 0 offen offset:128
  buffer_load_dwordx4 v[176:179], v10, s[8:11], 0 offen offset:192
  buffer_load_dwordx4 v[180:183], v10, s[8:11], 0 offen offset:256
  buffer_load_dwordx4 v[184:187], v10, s[8:11], 0 offen offset:320
  buffer_load_dwordx4 v[188:191], v10, s[8:11], 0 offen offset:384
  buffer_load_dwordx4 v[192:195], v10, s[8:11], 0 offen offset:448
  buffer_load_dwordx4 v[196:199], v10, s[8:11], 0 offen offset:512
  buffer_load_dwordx4 v[200:203], v10, s[8:11], 0 offen offset:576
  buffer_load_dwordx4 v[204:207], v10, s[8:11], 0 offen offset:640
  buffer_load_dwordx4 v[208:211], v10, s[8:11], 0 offen offset:704
  buffer_load_dwordx4 v[212:215], v10, s[8:11], 0 offen offset:768
  buffer_load_dwordx4 v[216:219], v10, s[8:11], 0 offen offset:832
  buffer_load_dwordx4 v[220:223], v10, s[8:11], 0 offen offset:896
  buffer_load_dwordx4 v[224:227], v10, s[8:11], 0 offen offset:960
  s_mov_b32 s31, 0
  s_or_b32 s6, s3, s5
  s_cmp_lg_u32 s6, 0
  s_cbranch_scc1 k1_kernel_nozero
  s_mov_b32 s31, 1
  v_lshlrev_b32 v4, 2, v1
  v_mov_b32 v228, 0
  v_mov_b32 v229, 0
  v_mov_b32 v230, 0
  v_mov_b32 v231, 0
  v_mov_b32 v232, 0
  v_mov_b32 v233, 0
  v_mov_b32 v234, 0
  v_mov_b32 v235, 0
  v_mov_b32 v236, 0
  v_mov_b32 v237, 0
  v_mov_b32 v238, 0
  v_mov_b32 v239, 0
  v_mov_b32 v240, 0
  v_mov_b32 v241, 0
  v_mov_b32 v242, 0
  v_mov_b32 v243, 0
  v_mov_b32 v244, 0
  buffer_atomic_swap v228, v4, s[24:27], 0 offen offset:0 sc0
  buffer_atomic_swap v229, v4, s[24:27], 0 offen offset:256 sc0
  buffer_atomic_swap v230, v4, s[24:27], 0 offen offset:512 sc0
  buffer_atomic_swap v231, v4, s[24:27], 0 offen offset:768 sc0
  buffer_atomic_swap v232, v4, s[24:27], 0 offen offset:1024 sc0
  buffer_atomic_swap v233, v4, s[24:27], 0 offen offset:1280 sc0
  buffer_atomic_swap v234, v4, s[24:27], 0 offen offset:1536 sc0
  buffer_atomic_swap v235, v4, s[24:27], 0 offen offset:1792 sc0
  buffer_atomic_swap v236, v4, s[24:27], 0 offen offset:2048 sc0
  buffer_atomic_swap v237, v4, s[24:27], 0 offen offset:2304 sc0
  buffer_atomic_swap v238, v4, s[24:27], 0 offen offset:2560 sc0
  buffer_atomic_swap v239, v4, s[24:27], 0 offen offset:2816 sc0
  buffer_atomic_swap v240, v4, s[24:27], 0 offen offset:3072 sc0
  buffer_atomic_swap v241, v4, s[24:27], 0 offen offset:3328 sc0
  buffer_atomic_swap v242, v4, s[24:27], 0 offen offset:3584 sc0
  buffer_atomic_swap v243, v4, s[24:27], 0 offen offset:3840 sc0
  s_movk_i32 s6, 4096
  buffer_atomic_swap v244, v4, s[24:27], s6 offen sc0
k1_kernel_nozero:
  s_and_b32 s6, s5, 1
  s_lshl_b32 s6, s6, 1
  v_lshrrev_b32 v4, 3, v1
  v_mul_u32_u24 v11, 3072, v4
  v_bfe_u32 v4, v1, 4, 1
  v_or_b32 v4, s6, v4
  v_bfe_u32 v5, v1, 1, 2
  v_xor_b32 v4, v4, v5
  v_and_b32 v5, 1, v1
  v_lshl_or_b32 v4, v4, 1, v5
  v_lshl_add_u32 v11, v4, 4, v11
  s_lshl_b32 s44, s5, 10
  s_mul_i32 s45, s5, 24576
  s_add_u32 m0, s44, 0
  s_add_u32 s7, s45, 0
  buffer_load_dwordx4 v11, s[12:15], s7 offen lds
  s_add_u32 m0, s44, 16384
  s_add_u32 s7, s45, 1024
  buffer_load_dwordx4 v11, s[12:15], s7 offen lds
  s_add_u32 m0, s44, 32768
  s_add_u32 s7, s45, 2048
  buffer_load_dwordx4 v11, s[12:15], s7 offen lds
  s_add_u32 m0, s44, 4096
  s_add_u32 s7, s45, 98304
  buffer_load_dwordx4 v11, s[12:15], s7 offen lds
  s_add_u32 m0, s44, 20480
  s_add_u32 s7, s45, 99328
  buffer_load_dwordx4 v11, s[12:15], s7 offen lds
  s_add_u32 m0, s44, 36864
  s_add_u32 s7, s45, 100352
  buffer_load_dwordx4 v11, s[12:15], s7 offen lds
  s_add_u32 m0, s44, 8192
  s_add_u32 s7, s45, 196608
  buffer_load_dwordx4 v11, s[12:15], s7 offen lds
  s_add_u32 m0, s44, 24576
  s_add_u32 s7, s45, 197632
  buffer_load_dwordx4 v11, s[12:15], s7 offen lds
  s_add_u32 m0, s44, 40960
  s_add_u32 s7, s45, 198656
  buffer_load_dwordx4 v11, s[12:15], s7 offen lds
  s_add_u32 m0, s44, 12288
  s_add_u32 s7, s45, 294912
  buffer_load_dwordx4 v11, s[12:15], s7 offen lds
  s_add_u32 m0, s44, 28672
  s_add_u32 s7, s45, 295936
  buffer_load_dwordx4 v11, s[12:15], s7 offen lds
  s_add_u32 m0, s44, 45056
  s_add_u32 s7, s45, 296960
  buffer_load_dwordx4 v11, s[12:15], s7 offen lds
  s_add_u32 m0, s44, 49152
  s_add_u32 s7, s45, 393216
  buffer_load_dwordx4 v11, s[12:15], s7 offen lds
  s_add_u32 m0, s44, 65536
  s_add_u32 s7, s45, 394240
  buffer_load_dwordx4 v11, s[12:15], s7 offen lds
  s_add_u32 m0, s44, 81920
  s_add_u32 s7, s45, 395264
  buffer_load_dwordx4 v11, s[12:15], s7 offen lds
  s_add_u32 m0, s44, 53248
  s_add_u32 s7, s45, 491520
  buffer_load_dwordx4 v11, s[12:15], s7 offen lds
  s_add_u32 m0, s44, 69632
  s_add_u32 s7, s45, 492544
  buffer_load_dwordx4 v11, s[12:15], s7 offen lds
  s_add_u32 m0, s44, 86016
  s_add_u32 s7, s45, 493568
  buffer_load_dwordx4 v11, s[12:15], s7 offen lds
  s_add_u32 m0, s44, 57344
  s_add_u32 s7, s45, 589824
  buffer_load_dwordx4 v11, s[12:15], s7 offen lds
  s_add_u32 m0, s44, 73728
  s_add_u32 s7, s45, 590848
  buffer_load_dwordx4 v11, s[12:15], s7 offen lds
  s_add_u32 m0, s44, 90112
  s_add_u32 s7, s45, 591872
  buffer_load_dwordx4 v11, s[12:15], s7 offen lds
  s_add_u32 m0, s44, 61440
  s_add_u32 s7, s45, 688128
  buffer_load_dwordx4 v11, s[12:15], s7 offen lds
  s_add_u32 m0, s44, 77824
  s_add_u32 s7, s45, 689152
  buffer_load_dwordx4 v11, s[12:15], s7 offen lds
  s_add_u32 m0, s44, 94208
  s_add_u32 s7, s45, 690176
  buffer_load_dwordx4 v11, s[12:15], s7 offen lds
  v_bfe_u32 v4, v1, 2, 2
  v_lshl_add_u32 v5, v2, 3, v4
  v_lshlrev_b32 v5, 7, v5
  v_and_b32 v6, 3, v1
  v_lshl_add_u32 v5, v6, 3, v5
  v_lshrrev_b32 v4, 1, v4
  v_and_b32 v6, 1, v2
  v_lshl_or_b32 v4, v6, 1, v4
  v_xor_b32 v6, 0, v4
  v_lshl_add_u32 v16, v6, 5, v5
  v_xor_b32 v6, 1, v4
  v_lshl_add_u32 v17, v6, 5, v5
  v_xor_b32 v6, 2, v4
  v_lshl_add_u32 v18, v6, 5, v5
  v_xor_b32 v6, 3, v4
  v_lshl_add_u32 v19, v6, 5, v5
  v_mov_b32 v14, 0
  v_mov_b32 v15, 0
  s_waitcnt vmcnt(24)
  v_dot2_f32_bf16 v14, v164, s30, v14
  v_dot2_f32_bf16 v15, v164, v164, v15
  v_dot2_f32_bf16 v14, v165, s30, v14
  v_dot2_f32_bf16 v15, v165, v165, v15
  v_dot2_f32_bf16 v14, v166, s30, v14
  v_dot2_f32_bf16 v15, v166, v166, v15
  v_dot2_f32_bf16 v14, v167, s30, v14
  v_dot2_f32_bf16 v15, v167, v167, v15
  v_dot2_f32_bf16 v14, v168, s30, v14
  v_dot2_f32_bf16 v15, v168, v168, v15
  v_dot2_f32_bf16 v14, v169, s30, v14
  v_dot2_f32_bf16 v15, v169, v169, v15
  v_dot2_f32_bf16 v14, v170, s30, v14
  v_dot2_f32_bf16 v15, v170, v170, v15
  v_dot2_f32_bf16 v14, v171, s30, v14
  v_dot2_f32_bf16 v15, v171, v171, v15
  v_dot2_f32_bf16 v14, v172, s30, v14
  v_dot2_f32_bf16 v15, v172, v172, v15
  v_dot2_f32_bf16 v14, v173, s30, v14
  v_dot2_f32_bf16 v15, v173, v173, v15
  v_dot2_f32_bf16 v14, v174, s30, v14
  v_dot2_f32_bf16 v15, v174, v174, v15
  v_dot2_f32_bf16 v14, v175, s30, v14
  v_dot2_f32_bf16 v15, v175, v175, v15
  v_dot2_f32_bf16 v14, v176, s30, v14
  v_dot2_f32_bf16 v15, v176, v176, v15
  v_dot2_f32_bf16 v14, v177, s30, v14
  v_dot2_f32_bf16 v15, v177, v177, v15
  v_dot2_f32_bf16 v14, v178, s30, v14
  v_dot2_f32_bf16 v15, v178, v178, v15
  v_dot2_f32_bf16 v14, v179, s30, v14
  v_dot2_f32_bf16 v15, v179, v179, v15
  v_dot2_f32_bf16 v14, v180, s30, v14
  v_dot2_f32_bf16 v15, v180, v180, v15
  v_dot2_f32_bf16 v14, v181, s30, v14
  v_dot2_f32_bf16 v15, v181, v181, v15
  v_dot2_f32_bf16 v14, v182, s30, v14
  v_dot2_f32_bf16 v15, v182, v182, v15
  v_dot2_f32_bf16 v14, v183, s30, v14
  v_dot2_f32_bf16 v15, v183, v183, v15
  v_dot2_f32_bf16 v14, v184, s30, v14
  v_dot2_f32_bf16 v15, v184, v184, v15
  v_dot2_f32_bf16 v14, v185, s30, v14
  v_dot2_f32_bf16 v15, v185, v185, v15
  v_dot2_f32_bf16 v14, v186, s30, v14
  v_dot2_f32_bf16 v15, v186, v186, v15
  v_dot2_f32_bf16 v14, v187, s30, v14
  v_dot2_f32_bf16 v15, v187, v187, v15
  v_dot2_f32_bf16 v14, v188, s30, v14
  v_dot2_f32_bf16 v15, v188, v188, v15
  v_dot2_f32_bf16 v14, v189, s30, v14
  v_dot2_f32_bf16 v15, v189, v189, v15
  v_dot2_f32_bf16 v14, v190, s30, v14
  v_dot2_f32_bf16 v15, v190, v190, v15
  v_dot2_f32_bf16 v14, v191, s30, v14
  v_dot2_f32_bf16 v15, v191, v191, v15
  v_dot2_f32_bf16 v14, v192, s30, v14
  v_dot2_f32_bf16 v15, v192, v192, v15
  v_dot2_f32_bf16 v14, v193, s30, v14
  v_dot2_f32_bf16 v15, v193, v193, v15
  v_dot2_f32_bf16 v14, v194, s30, v14
  v_dot2_f32_bf16 v15, v194, v194, v15
  v_dot2_f32_bf16 v14, v195, s30, v14
  v_dot2_f32_bf16 v15, v195, v195, v15
  v_dot2_f32_bf16 v14, v196, s30, v14
  v_dot2_f32_bf16 v15, v196, v196, v15
  v_dot2_f32_bf16 v14, v197, s30, v14
  v_dot2_f32_bf16 v15, v197, v197, v15
  v_dot2_f32_bf16 v14, v198, s30, v14
  v_dot2_f32_bf16 v15, v198, v198, v15
  v_dot2_f32_bf16 v14, v199, s30, v14
  v_dot2_f32_bf16 v15, v199, v199, v15
  v_dot2_f32_bf16 v14, v200, s30, v14
  v_dot2_f32_bf16 v15, v200, v200, v15
  v_dot2_f32_bf16 v14, v201, s30, v14
  v_dot2_f32_bf16 v15, v201, v201, v15
  v_dot2_f32_bf16 v14, v202, s30, v14
  v_dot2_f32_bf16 v15, v202, v202, v15
  v_dot2_f32_bf16 v14, v203, s30, v14
  v_dot2_f32_bf16 v15, v203, v203, v15
  v_dot2_f32_bf16 v14, v204, s30, v14
  v_dot2_f32_bf16 v15, v204, v204, v15
  v_dot2_f32_bf16 v14, v205, s30, v14
  v_dot2_f32_bf16 v15, v205, v205, v15
  v_dot2_f32_bf16 v14, v206, s30, v14
  v_dot2_f32_bf16 v15, v206, v206, v15
  v_dot2_f32_bf16 v14, v207, s30, v14
  v_dot2_f32_bf16 v15, v207, v207, v15
  v_dot2_f32_bf16 v14, v208, s30, v14
  v_dot2_f32_bf16 v15, v208, v208, v15
  v_dot2_f32_bf16 v14, v209, s30, v14
  v_dot2_f32_bf16 v15, v209, v209, v15
  v_dot2_f32_bf16 v14, v210, s30, v14
  v_dot2_f32_bf16 v15, v210, v210, v15
  v_dot2_f32_bf16 v14, v211, s30, v14
  v_dot2_f32_bf16 v15, v211, v211, v15
  v_dot2_f32_bf16 v14, v212, s30, v14
  v_dot2_f32_bf16 v15, v212, v212, v15
  v_dot2_f32_bf16 v14, v213, s30, v14
  v_dot2_f32_bf16 v15, v213, v213, v15
  v_dot2_f32_bf16 v14, v214, s30, v14
  v_dot2_f32_bf16 v15, v214, v214, v15
  v_dot2_f32_bf16 v14, v215, s30, v14
  v_dot2_f32_bf16 v15, v215, v215, v15
  v_dot2_f32_bf16 v14, v216, s30, v14
  v_dot2_f32_bf16 v15, v216, v216, v15
  v_dot2_f32_bf16 v14, v217, s30, v14
  v_dot2_f32_bf16 v15, v217, v217, v15
  v_dot2_f32_bf16 v14, v218, s30, v14
  v_dot2_f32_bf16 v15, v218, v218, v15
  v_dot2_f32_bf16 v14, v219, s30, v14
  v_dot2_f32_bf16 v15, v219, v219, v15
  v_dot2_f32_bf16 v14, v220, s30, v14
  v_dot2_f32_bf16 v15, v220, v220, v15
  v_dot2_f32_bf16 v14, v221, s30, v14
  v_dot2_f32_bf16 v15, v221, v221, v15
  v_dot2_f32_bf16 v14, v222, s30, v14
  v_dot2_f32_bf16 v15, v222, v222, v15
  v_dot2_f32_bf16 v14, v223, s30, v14
  v_dot2_f32_bf16 v15, v223, v223, v15
  v_dot2_f32_bf16 v14, v224, s30, v14
  v_dot2_f32_bf16 v15, v224, v224, v15
  v_dot2_f32_bf16 v14, v225, s30, v14
  v_dot2_f32_bf16 v15, v225, v225, v15
  v_dot2_f32_bf16 v14, v226, s30, v14
  v_dot2_f32_bf16 v15, v226, v226, v15
  v_dot2_f32_bf16 v14, v227, s30, v14
  v_dot2_f32_bf16 v15, v227, v227, v15
  s_nop 3
  v_mov_b32 v4, v14
  s_nop 1
  v_permlane16_swap_b32 v14, v4
  v_add_f32 v14, v14, v4
  v_mov_b32 v4, v14
  s_nop 1
  v_permlane32_swap_b32 v14, v4
  v_add_f32 v14, v14, v4
  v_mov_b32 v4, v15
  s_nop 1
  v_permlane16_swap_b32 v15, v4
  v_add_f32 v15, v15, v4
  v_mov_b32 v4, v15
  s_nop 1
  v_permlane32_swap_b32 v15, v4
  v_add_f32 v15, v15, v4
  v_mul_f32 v12, 0x3b000000, v14
  v_mul_f32 v4, 0x3b000000, v15
  v_fma_f32 v4, -v12, v12, v4
  v_max_f32 v4, 0, v4
  v_cvt_pk_bf16_f32 v12, v12, v12
  v_lshlrev_b32 v12, 16, v12
  v_cvt_pk_bf16_f32 v4, v4, v4
  v_lshlrev_b32 v4, 16, v4
  v_add_f32 v4, 0x3727c5ac, v4
  v_cvt_pk_bf16_f32 v4, v4, v4
  v_lshlrev_b32 v4, 16, v4
  v_sqrt_f32 v4, v4
  s_nop 0
  v_cvt_pk_bf16_f32 v4, v4, v4
  v_lshlrev_b32 v4, 16, v4
  v_rcp_f32 v13, v4
  s_nop 0
  v_mov_b32 v14, v13
  v_sub_f32 v12, 0, v12
  v_lshlrev_b32 v4, 16, v164
  v_and_b32 v5, 0xffff0000, v164
  v_pk_add_f32 v[4:5], v[4:5], v[12:13] op_sel_hi:[1,0]
  v_cvt_pk_bf16_f32 v164, v4, v5
  v_lshlrev_b32 v6, 16, v165
  v_and_b32 v7, 0xffff0000, v165
  v_pk_add_f32 v[6:7], v[6:7], v[12:13] op_sel_hi:[1,0]
  v_cvt_pk_bf16_f32 v165, v6, v7
  v_lshlrev_b32 v8, 16, v166
  v_and_b32 v9, 0xffff0000, v166
  v_pk_add_f32 v[8:9], v[8:9], v[12:13] op_sel_hi:[1,0]
  v_cvt_pk_bf16_f32 v166, v8, v9
  v_lshlrev_b32 v4, 16, v167
  v_and_b32 v5, 0xffff0000, v167
  v_pk_add_f32 v[4:5], v[4:5], v[12:13] op_sel_hi:[1,0]
  v_cvt_pk_bf16_f32 v167, v4, v5
  s_waitcnt vmcnt(12)
  s_cmp_lg_u32 s31, 1
  s_cbranch_scc1 k1_kernel_noflag
  s_mov_b64 exec, 1
  v_mov_b32 v4, s4
  v_lshlrev_b32 v4, 2, v4
  v_mov_b32 v5, 1
  buffer_store_dword v5, v4, s[20:23], 0 offen sc0 sc1
  s_mov_b64 exec, -1
k1_kernel_noflag:
  s_barrier
  ds_read_b64_tr_b16 v[68:69], v16 offset:0
  ds_read_b64_tr_b16 v[70:71], v16 offset:512
  ds_read_b64_tr_b16 v[72:73], v17 offset:0
  ds_read_b64_tr_b16 v[74:75], v17 offset:512
  ds_read_b64_tr_b16 v[76:77], v18 offset:0
  ds_read_b64_tr_b16 v[78:79], v18 offset:512
  ds_read_b64_tr_b16 v[80:81], v19 offset:0
  ds_read_b64_tr_b16 v[82:83], v19 offset:512
  ds_read_b64_tr_b16 v[84:85], v16 offset:16384
  ds_read_b64_tr_b16 v[86:87], v16 offset:16896
  ds_read_b64_tr_b16 v[88:89], v17 offset:16384
  ds_read_b64_tr_b16 v[90:91], v17 offset:16896
  ds_read_b64_tr_b16 v[92:93], v18 offset:16384
  ds_read_b64_tr_b16 v[94:95], v18 offset:16896
  ds_read_b64_tr_b16 v[96:97], v19 offset:16384
  ds_read_b64_tr_b16 v[98:99], v19 offset:16896
  ds_read_b64_tr_b16 v[100:101], v16 offset:32768
  ds_read_b64_tr_b16 v[102:103], v16 offset:33280
  ds_read_b64_tr_b16 v[104:105], v17 offset:32768
  ds_read_b64_tr_b16 v[106:107], v17 offset:33280
  ds_read_b64_tr_b16 v[108:109], v18 offset:32768
  ds_read_b64_tr_b16 v[110:111], v18 offset:33280
  ds_read_b64_tr_b16 v[112:113], v19 offset:32768
  ds_read_b64_tr_b16 v[114:115], v19 offset:33280
  s_waitcnt lgkmcnt(0)
  s_nop 1
  v_mfma_f32_16x16x32_bf16 v[20:23], v[68:71], v[164:167], 0
  ds_read_b64_tr_b16 v[116:117], v16 offset:4096
  ds_read_b64_tr_b16 v[118:119], v16 offset:4608
  ds_read_b64_tr_b16 v[120:121], v17 offset:4096
  v_mfma_f32_16x16x32_bf16 v[24:27], v[72:75], v[164:167], 0
  ds_read_b64_tr_b16 v[122:123], v17 offset:4608
  ds_read_b64_tr_b16 v[124:125], v18 offset:4096
  v_mfma_f32_16x16x32_bf16 v[28:31], v[76:79], v[164:167], 0
  v_lshlrev_b32 v4, 16, v168
  v_and_b32 v5, 0xffff0000, v168
  v_pk_add_f32 v[4:5], v[4:5], v[12:13] op_sel_hi:[1,0]
  v_cvt_pk_bf16_f32 v168, v4, v5
  ds_read_b64_tr_b16 v[126:127], v18 offset:4608
  v_mfma_f32_16x16x32_bf16 v[32:35], v[80:83], v[164:167], 0
  ds_read_b64_tr_b16 v[128:129], v19 offset:4096
  ds_read_b64_tr_b16 v[130:131], v19 offset:4608
  ds_read_b64_tr_b16 v[132:133], v16 offset:20480
  v_mfma_f32_16x16x32_bf16 v[36:39], v[164:167], v[84:87], 0
  ds_read_b64_tr_b16 v[134:135], v16 offset:20992
  v_lshlrev_b32 v6, 16, v169
  v_and_b32 v7, 0xffff0000, v169
  v_pk_add_f32 v[6:7], v[6:7], v[12:13] op_sel_hi:[1,0]
  v_cvt_pk_bf16_f32 v169, v6, v7
  v_mfma_f32_16x16x32_bf16 v[40:43], v[164:167], v[88:91], 0
  ds_read_b64_tr_b16 v[136:137], v17 offset:20480
  ds_read_b64_tr_b16 v[138:139], v17 offset:20992
  v_mfma_f32_16x16x32_bf16 v[44:47], v[164:167], v[92:95], 0
  ds_read_b64_tr_b16 v[140:141], v18 offset:20480
  ds_read_b64_tr_b16 v[142:143], v18 offset:20992
  ds_read_b64_tr_b16 v[144:145], v19 offset:20480
  v_mfma_f32_16x16x32_bf16 v[48:51], v[164:167], v[96:99], 0
  v_lshlrev_b32 v8, 16, v170
  v_and_b32 v9, 0xffff0000, v170
  v_pk_add_f32 v[8:9], v[8:9], v[12:13] op_sel_hi:[1,0]
  v_cvt_pk_bf16_f32 v170, v8, v9
  ds_read_b64_tr_b16 v[146:147], v19 offset:20992
  v_mfma_f32_16x16x32_bf16 v[52:55], v[164:167], v[100:103], 0
  ds_read_b64_tr_b16 v[148:149], v16 offset:36864
  ds_read_b64_tr_b16 v[150:151], v16 offset:37376
  v_mfma_f32_16x16x32_bf16 v[56:59], v[164:167], v[104:107], 0
  ds_read_b64_tr_b16 v[152:153], v17 offset:36864
  ds_read_b64_tr_b16 v[154:155], v17 offset:37376
  v_lshlrev_b32 v4, 16, v171
  v_and_b32 v5, 0xffff0000, v171
  v_pk_add_f32 v[4:5], v[4:5], v[12:13] op_sel_hi:[1,0]
  v_cvt_pk_bf16_f32 v171, v4, v5
  v_mfma_f32_16x16x32_bf16 v[60:63], v[164:167], v[108:111], 0
  ds_read_b64_tr_b16 v[156:157], v18 offset:36864
  ds_read_b64_tr_b16 v[158:159], v18 offset:37376
  v_mfma_f32_16x16x32_bf16 v[64:67], v[164:167], v[112:115], 0
  ds_read_b64_tr_b16 v[160:161], v19 offset:36864
  ds_read_b64_tr_b16 v[162:163], v19 offset:37376
  s_waitcnt lgkmcnt(0)
  s_nop 1
  v_mfma_f32_16x16x32_bf16 v[20:23], v[116:119], v[168:171], v[20:23]
  ds_read_b64_tr_b16 v[68:69], v16 offset:8192
  ds_read_b64_tr_b16 v[70:71], v16 offset:8704
  ds_read_b64_tr_b16 v[72:73], v17 offset:8192
  v_mfma_f32_16x16x32_bf16 v[24:27], v[120:123], v[168:171], v[24:27]
  ds_read_b64_tr_b16 v[74:75], v17 offset:8704
  ds_read_b64_tr_b16 v[76:77], v18 offset:8192
  v_mfma_f32_16x16x32_bf16 v[28:31], v[124:127], v[168:171], v[28:31]
  v_lshlrev_b32 v4, 16, v172
  v_and_b32 v5, 0xffff0000, v172
  v_pk_add_f32 v[4:5], v[4:5], v[12:13] op_sel_hi:[1,0]
  v_cvt_pk_bf16_f32 v172, v4, v5
  ds_read_b64_tr_b16 v[78:79], v18 offset:8704
  v_mfma_f32_16x16x32_bf16 v[32:35], v[128:131], v[168:171], v[32:35]
  ds_read_b64_tr_b16 v[80:81], v19 offset:8192
  ds_read_b64_tr_b16 v[82:83], v19 offset:8704
  ds_read_b64_tr_b16 v[84:85], v16 offset:24576
  v_mfma_f32_16x16x32_bf16 v[36:39], v[168:171], v[132:135], v[36:39]
  ds_read_b64_tr_b16 v[86:87], v16 offset:25088
  v_lshlrev_b32 v6, 16, v173
  v_and_b32 v7, 0xffff0000, v173
  v_pk_add_f32 v[6:7], v[6:7], v[12:13] op_sel_hi:[1,0]
  v_cvt_pk_bf16_f32 v173, v6, v7
  v_mfma_f32_16x16x32_bf16 v[40:43], v[168:171], v[136:139], v[40:43]
  ds_read_b64_tr_b16 v[88:89], v17 offset:24576
  ds_read_b64_tr_b16 v[90:91], v17 offset:25088
  v_mfma_f32_16x16x32_bf16 v[44:47], v[168:171], v[140:143], v[44:47]
  ds_read_b64_tr_b16 v[92:93], v18 offset:24576
  ds_read_b64_tr_b16 v[94:95], v18 offset:25088
  ds_read_b64_tr_b16 v[96:97], v19 offset:24576
  v_mfma_f32_16x16x32_bf16 v[48:51], v[168:171], v[144:147], v[48:51]
  v_lshlrev_b32 v8, 16, v174
  v_and_b32 v9, 0xffff0000, v174
  v_pk_add_f32 v[8:9], v[8:9], v[12:13] op_sel_hi:[1,0]
  v_cvt_pk_bf16_f32 v174, v8, v9
  ds_read_b64_tr_b16 v[98:99], v19 offset:25088
  v_mfma_f32_16x16x32_bf16 v[52:55], v[168:171], v[148:151], v[52:55]
  ds_read_b64_tr_b16 v[100:101], v16 offset:40960
  ds_read_b64_tr_b16 v[102:103], v16 offset:41472
  v_mfma_f32_16x16x32_bf16 v[56:59], v[168:171], v[152:155], v[56:59]
  ds_read_b64_tr_b16 v[104:105], v17 offset:40960
  ds_read_b64_tr_b16 v[106:107], v17 offset:41472
  v_lshlrev_b32 v4, 16, v175
  v_and_b32 v5, 0xffff0000, v175
  v_pk_add_f32 v[4:5], v[4:5], v[12:13] op_sel_hi:[1,0]
  v_cvt_pk_bf16_f32 v175, v4, v5
  v_mfma_f32_16x16x32_bf16 v[60:63], v[168:171], v[156:159], v[60:63]
  ds_read_b64_tr_b16 v[108:109], v18 offset:40960
  ds_read_b64_tr_b16 v[110:111], v18 offset:41472
  v_mfma_f32_16x16x32_bf16 v[64:67], v[168:171], v[160:163], v[64:67]
  ds_read_b64_tr_b16 v[112:113], v19 offset:40960
  ds_read_b64_tr_b16 v[114:115], v19 offset:41472
  s_waitcnt lgkmcnt(0)
  s_nop 1
  v_mfma_f32_16x16x32_bf16 v[20:23], v[68:71], v[172:175], v[20:23]
  ds_read_b64_tr_b16 v[116:117], v16 offset:12288
  ds_read_b64_tr_b16 v[118:119], v16 offset:12800
  ds_read_b64_tr_b16 v[120:121], v17 offset:12288
  v_mfma_f32_16x16x32_bf16 v[24:27], v[72:75], v[172:175], v[24:27]
  ds_read_b64_tr_b16 v[122:123], v17 offset:12800
  ds_read_b64_tr_b16 v[124:125], v18 offset:12288
  v_mfma_f32_16x16x32_bf16 v[28:31], v[76:79], v[172:175], v[28:31]
  v_lshlrev_b32 v4, 16, v176
  v_and_b32 v5, 0xffff0000, v176
  v_pk_add_f32 v[4:5], v[4:5], v[12:13] op_sel_hi:[1,0]
  v_cvt_pk_bf16_f32 v176, v4, v5
  ds_read_b64_tr_b16 v[126:127], v18 offset:12800
  v_mfma_f32_16x16x32_bf16 v[32:35], v[80:83], v[172:175], v[32:35]
  ds_read_b64_tr_b16 v[128:129], v19 offset:12288
  ds_read_b64_tr_b16 v[130:131], v19 offset:12800
  ds_read_b64_tr_b16 v[132:133], v16 offset:28672
  v_mfma_f32_16x16x32_bf16 v[36:39], v[172:175], v[84:87], v[36:39]
  ds_read_b64_tr_b16 v[134:135], v16 offset:29184
  v_lshlrev_b32 v6, 16, v177
  v_and_b32 v7, 0xffff0000, v177
  v_pk_add_f32 v[6:7], v[6:7], v[12:13] op_sel_hi:[1,0]
  v_cvt_pk_bf16_f32 v177, v6, v7
  v_mfma_f32_16x16x32_bf16 v[40:43], v[172:175], v[88:91], v[40:43]
  ds_read_b64_tr_b16 v[136:137], v17 offset:28672
  ds_read_b64_tr_b16 v[138:139], v17 offset:29184
  v_mfma_f32_16x16x32_bf16 v[44:47], v[172:175], v[92:95], v[44:47]
  ds_read_b64_tr_b16 v[140:141], v18 offset:28672
  ds_read_b64_tr_b16 v[142:143], v18 offset:29184
  ds_read_b64_tr_b16 v[144:145], v19 offset:28672
  v_mfma_f32_16x16x32_bf16 v[48:51], v[172:175], v[96:99], v[48:51]
  v_lshlrev_b32 v8, 16, v178
  v_and_b32 v9, 0xffff0000, v178
  v_pk_add_f32 v[8:9], v[8:9], v[12:13] op_sel_hi:[1,0]
  v_cvt_pk_bf16_f32 v178, v8, v9
  ds_read_b64_tr_b16 v[146:147], v19 offset:29184
  v_mfma_f32_16x16x32_bf16 v[52:55], v[172:175], v[100:103], v[52:55]
  ds_read_b64_tr_b16 v[148:149], v16 offset:45056
  ds_read_b64_tr_b16 v[150:151], v16 offset:45568
  v_mfma_f32_16x16x32_bf16 v[56:59], v[172:175], v[104:107], v[56:59]
  ds_read_b64_tr_b16 v[152:153], v17 offset:45056
  ds_read_b64_tr_b16 v[154:155], v17 offset:45568
  v_lshlrev_b32 v4, 16, v179
  v_and_b32 v5, 0xffff0000, v179
  v_pk_add_f32 v[4:5], v[4:5], v[12:13] op_sel_hi:[1,0]
  v_cvt_pk_bf16_f32 v179, v4, v5
  v_mfma_f32_16x16x32_bf16 v[60:63], v[172:175], v[108:111], v[60:63]
  ds_read_b64_tr_b16 v[156:157], v18 offset:45056
  ds_read_b64_tr_b16 v[158:159], v18 offset:45568
  v_mfma_f32_16x16x32_bf16 v[64:67], v[172:175], v[112:115], v[64:67]
  ds_read_b64_tr_b16 v[160:161], v19 offset:45056
  ds_read_b64_tr_b16 v[162:163], v19 offset:45568
  s_waitcnt vmcnt(0)
  s_barrier
  s_waitcnt lgkmcnt(0)
  s_nop 1
  v_mfma_f32_16x16x32_bf16 v[20:23], v[116:119], v[176:179], v[20:23]
  v_add_u32 v16, 49152, v16
  v_add_u32 v17, 49152, v17
  v_add_u32 v18, 49152, v18
  v_mfma_f32_16x16x32_bf16 v[24:27], v[120:123], v[176:179], v[24:27]
  v_add_u32 v19, 49152, v19
  ds_read_b64_tr_b16 v[68:69], v16 offset:0
  v_lshlrev_b32 v4, 16, v180
  v_and_b32 v5, 0xffff0000, v180
  v_pk_add_f32 v[4:5], v[4:5], v[12:13] op_sel_hi:[1,0]
  v_cvt_pk_bf16_f32 v180, v4, v5
  v_mfma_f32_16x16x32_bf16 v[28:31], v[124:127], v[176:179], v[28:31]
  s_add_u32 m0, s44, 98304
  s_add_u32 s7, s45, 786432
  buffer_load_dwordx4 v11, s[12:15], s7 offen lds
  ds_read_b64_tr_b16 v[70:71], v16 offset:512
  ds_read_b64_tr_b16 v[72:73], v17 offset:0
  v_mfma_f32_16x16x32_bf16 v[32:35], v[128:131], v[176:179], v[32:35]
  ds_read_b64_tr_b16 v[74:75], v17 offset:512
  ds_read_b64_tr_b16 v[76:77], v18 offset:0
  ds_read_b64_tr_b16 v[78:79], v18 offset:512
  v_mfma_f32_16x16x32_bf16 v[36:39], v[176:179], v[132:135], v[36:39]
  v_lshlrev_b32 v6, 16, v181
  v_and_b32 v7, 0xffff0000, v181
  v_pk_add_f32 v[6:7], v[6:7], v[12:13] op_sel_hi:[1,0]
  v_cvt_pk_bf16_f32 v181, v6, v7
  s_add_u32 m0, s44, 114688
  s_add_u32 s7, s45, 787456
  buffer_load_dwordx4 v11, s[12:15], s7 offen lds
  ds_read_b64_tr_b16 v[80:81], v19 offset:0
  v_mfma_f32_16x16x32_bf16 v[40:43], v[176:179], v[136:139], v[40:43]
  ds_read_b64_tr_b16 v[82:83], v19 offset:512
  ds_read_b64_tr_b16 v[84:85], v16 offset:16384
  ds_read_b64_tr_b16 v[86:87], v16 offset:16896
  v_mfma_f32_16x16x32_bf16 v[44:47], v[176:179], v[140:143], v[44:47]
  ds_read_b64_tr_b16 v[88:89], v17 offset:16384
  v_lshlrev_b32 v8, 16, v182
  v_and_b32 v9, 0xffff0000, v182
  v_pk_add_f32 v[8:9], v[8:9], v[12:13] op_sel_hi:[1,0]
  v_cvt_pk_bf16_f32 v182, v8, v9
  s_add_u32 m0, s44, 131072
  s_add_u32 s7, s45, 788480
  buffer_load_dwordx4 v11, s[12:15], s7 offen lds
  v_mfma_f32_16x16x32_bf16 v[48:51], v[176:179], v[144:147], v[48:51]
  ds_read_b64_tr_b16 v[90:91], v17 offset:16896
  ds_read_b64_tr_b16 v[92:93], v18 offset:16384
  ds_read_b64_tr_b16 v[94:95], v18 offset:16896
  v_mfma_f32_16x16x32_bf16 v[52:55], v[176:179], v[148:151], v[52:55]
  ds_read_b64_tr_b16 v[96:97], v19 offset:16384
  ds_read_b64_tr_b16 v[98:99], v19 offset:16896
  v_lshlrev_b32 v4, 16, v183
  v_and_b32 v5, 0xffff0000, v183
  v_pk_add_f32 v[4:5], v[4:5], v[12:13] op_sel_hi:[1,0]
  v_cvt_pk_bf16_f32 v183, v4, v5
  v_mfma_f32_16x16x32_bf16 v[56:59], v[176:179], v[152:155], v[56:59]
  s_add_u32 m0, s44, 102400
  s_add_u32 s7, s45, 884736
  buffer_load_dwordx4 v11, s[12:15], s7 offen lds
  ds_read_b64_tr_b16 v[100:101], v16 offset:32768
  ds_read_b64_tr_b16 v[102:103], v16 offset:33280
  v_mfma_f32_16x16x32_bf16 v[60:63], v[176:179], v[156:159], v[60:63]
  ds_read_b64_tr_b16 v[104:105], v17 offset:32768
  ds_read_b64_tr_b16 v[106:107], v17 offset:33280
  ds_read_b64_tr_b16 v[108:109], v18 offset:32768
  v_mfma_f32_16x16x32_bf16 v[64:67], v[176:179], v[160:163], v[64:67]
  ds_read_b64_tr_b16 v[110:111], v18 offset:33280
  ds_read_b64_tr_b16 v[112:113], v19 offset:32768
  ds_read_b64_tr_b16 v[114:115], v19 offset:33280
  s_waitcnt lgkmcnt(0)
  s_nop 1
  v_mfma_f32_16x16x32_bf16 v[20:23], v[68:71], v[180:183], v[20:23]
  ds_read_b64_tr_b16 v[116:117], v16 offset:4096
  ds_read_b64_tr_b16 v[118:119], v16 offset:4608
  ds_read_b64_tr_b16 v[120:121], v17 offset:4096
  v_mfma_f32_16x16x32_bf16 v[24:27], v[72:75], v[180:183], v[24:27]
  ds_read_b64_tr_b16 v[122:123], v17 offset:4608
  ds_read_b64_tr_b16 v[124:125], v18 offset:4096
  v_lshlrev_b32 v4, 16, v184
  v_and_b32 v5, 0xffff0000, v184
  v_pk_add_f32 v[4:5], v[4:5], v[12:13] op_sel_hi:[1,0]
  v_cvt_pk_bf16_f32 v184, v4, v5
  v_mfma_f32_16x16x32_bf16 v[28:31], v[76:79], v[180:183], v[28:31]
  s_add_u32 m0, s44, 118784
  s_add_u32 s7, s45, 885760
  buffer_load_dwordx4 v11, s[12:15], s7 offen lds
  ds_read_b64_tr_b16 v[126:127], v18 offset:4608
  v_mfma_f32_16x16x32_bf16 v[32:35], v[80:83], v[180:183], v[32:35]
  ds_read_b64_tr_b16 v[128:129], v19 offset:4096
  ds_read_b64_tr_b16 v[130:131], v19 offset:4608
  ds_read_b64_tr_b16 v[132:133], v16 offset:20480
  v_mfma_f32_16x16x32_bf16 v[36:39], v[180:183], v[84:87], v[36:39]
  ds_read_b64_tr_b16 v[134:135], v16 offset:20992
  v_lshlrev_b32 v6, 16, v185
  v_and_b32 v7, 0xffff0000, v185
  v_pk_add_f32 v[6:7], v[6:7], v[12:13] op_sel_hi:[1,0]
  v_cvt_pk_bf16_f32 v185, v6, v7
  s_add_u32 m0, s44, 135168
  s_add_u32 s7, s45, 886784
  buffer_load_dwordx4 v11, s[12:15], s7 offen lds
  v_mfma_f32_16x16x32_bf16 v[40:43], v[180:183], v[88:91], v[40:43]
  ds_read_b64_tr_b16 v[136:137], v17 offset:20480
  ds_read_b64_tr_b16 v[138:139], v17 offset:20992
  v_mfma_f32_16x16x32_bf16 v[44:47], v[180:183], v[92:95], v[44:47]
  ds_read_b64_tr_b16 v[140:141], v18 offset:20480
  ds_read_b64_tr_b16 v[142:143], v18 offset:20992
  ds_read_b64_tr_b16 v[144:145], v19 offset:20480
  v_mfma_f32_16x16x32_bf16 v[48:51], v[180:183], v[96:99], v[48:51]
  v_lshlrev_b32 v8, 16, v186
  v_and_b32 v9, 0xffff0000, v186
  v_pk_add_f32 v[8:9], v[8:9], v[12:13] op_sel_hi:[1,0]
  v_cvt_pk_bf16_f32 v186, v8, v9
  s_add_u32 m0, s44, 106496
  s_add_u32 s7, s45, 983040
  buffer_load_dwordx4 v11, s[12:15], s7 offen lds
  ds_read_b64_tr_b16 v[146:147], v19 offset:20992
  v_mfma_f32_16x16x32_bf16 v[52:55], v[180:183], v[100:103], v[52:55]
  ds_read_b64_tr_b16 v[148:149], v16 offset:36864
  ds_read_b64_tr_b16 v[150:151], v16 offset:37376
  v_mfma_f32_16x16x32_bf16 v[56:59], v[180:183], v[104:107], v[56:59]
  ds_read_b64_tr_b16 v[152:153], v17 offset:36864
  ds_read_b64_tr_b16 v[154:155], v17 offset:37376
  v_lshlrev_b32 v4, 16, v187
  v_and_b32 v5, 0xffff0000, v187
  v_pk_add_f32 v[4:5], v[4:5], v[12:13] op_sel_hi:[1,0]
  v_cvt_pk_bf16_f32 v187, v4, v5
  v_mfma_f32_16x16x32_bf16 v[60:63], v[180:183], v[108:111], v[60:63]
  s_add_u32 m0, s44, 122880
  s_add_u32 s7, s45, 984064
  buffer_load_dwordx4 v11, s[12:15], s7 offen lds
  ds_read_b64_tr_b16 v[156:157], v18 offset:36864
  ds_read_b64_tr_b16 v[158:159], v18 offset:37376
  v_mfma_f32_16x16x32_bf16 v[64:67], v[180:183], v[112:115], v[64:67]
  ds_read_b64_tr_b16 v[160:161], v19 offset:36864
  ds_read_b64_tr_b16 v[162:163], v19 offset:37376
  s_waitcnt lgkmcnt(0)
  s_nop 1
  v_mfma_f32_16x16x32_bf16 v[20:23], v[116:119], v[184:187], v[20:23]
  ds_read_b64_tr_b16 v[68:69], v16 offset:8192
  ds_read_b64_tr_b16 v[70:71], v16 offset:8704
  ds_read_b64_tr_b16 v[72:73], v17 offset:8192
  v_mfma_f32_16x16x32_bf16 v[24:27], v[120:123], v[184:187], v[24:27]
  ds_read_b64_tr_b16 v[74:75], v17 offset:8704
  ds_read_b64_tr_b16 v[76:77], v18 offset:8192
  v_lshlrev_b32 v4, 16, v188
  v_and_b32 v5, 0xffff0000, v188
  v_pk_add_f32 v[4:5], v[4:5], v[12:13] op_sel_hi:[1,0]
  v_cvt_pk_bf16_f32 v188, v4, v5
  v_mfma_f32_16x16x32_bf16 v[28:31], v[124:127], v[184:187], v[28:31]
  s_add_u32 m0, s44, 139264
  s_add_u32 s7, s45, 985088
  buffer_load_dwordx4 v11, s[12:15], s7 offen lds
  ds_read_b64_tr_b16 v[78:79], v18 offset:8704
  v_mfma_f32_16x16x32_bf16 v[32:35], v[128:131], v[184:187], v[32:35]
  ds_read_b64_tr_b16 v[80:81], v19 offset:8192
  ds_read_b64_tr_b16 v[82:83], v19 offset:8704
  ds_read_b64_tr_b16 v[84:85], v16 offset:24576
  v_mfma_f32_16x16x32_bf16 v[36:39], v[184:187], v[132:135], v[36:39]
  ds_read_b64_tr_b16 v[86:87], v16 offset:25088
  v_lshlrev_b32 v6, 16, v189
  v_and_b32 v7, 0xffff0000, v189
  v_pk_add_f32 v[6:7], v[6:7], v[12:13] op_sel_hi:[1,0]
  v_cvt_pk_bf16_f32 v189, v6, v7
  s_add_u32 m0, s44, 110592
  s_add_u32 s7, s45, 1081344
  buffer_load_dwordx4 v11, s[12:15], s7 offen lds
  v_mfma_f32_16x16x32_bf16 v[40:43], v[184:187], v[136:139], v[40:43]
  ds_read_b64_tr_b16 v[88:89], v17 offset:24576
  ds_read_b64_tr_b16 v[90:91], v17 offset:25088
  v_mfma_f32_16x16x32_bf16 v[44:47], v[184:187], v[140:143], v[44:47]
  ds_read_b64_tr_b16 v[92:93], v18 offset:24576
  ds_read_b64_tr_b16 v[94:95], v18 offset:25088
  ds_read_b64_tr_b16 v[96:97], v19 offset:24576
  v_mfma_f32_16x16x32_bf16 v[48:51], v[184:187], v[144:147], v[48:51]
  v_lshlrev_b32 v8, 16, v190
  v_and_b32 v9, 0xffff0000, v190
  v_pk_add_f32 v[8:9], v[8:9], v[12:13] op_sel_hi:[1,0]
  v_cvt_pk_bf16_f32 v190, v8, v9
  s_add_u32 m0, s44, 126976
  s_add_u32 s7, s45, 1082368
  buffer_load_dwordx4 v11, s[12:15], s7 offen lds
  ds_read_b64_tr_b16 v[98:99], v19 offset:25088
  v_mfma_f32_16x16x32_bf16 v[52:55], v[184:187], v[148:151], v[52:55]
  ds_read_b64_tr_b16 v[100:101], v16 offset:40960
  ds_read_b64_tr_b16 v[102:103], v16 offset:41472
  v_mfma_f32_16x16x32_bf16 v[56:59], v[184:187], v[152:155], v[56:59]
  ds_read_b64_tr_b16 v[104:105], v17 offset:40960
  ds_read_b64_tr_b16 v[106:107], v17 offset:41472
  v_lshlrev_b32 v4, 16, v191
  v_and_b32 v5, 0xffff0000, v191
  v_pk_add_f32 v[4:5], v[4:5], v[12:13] op_sel_hi:[1,0]
  v_cvt_pk_bf16_f32 v191, v4, v5
  v_mfma_f32_16x16x32_bf16 v[60:63], v[184:187], v[156:159], v[60:63]
  s_add_u32 m0, s44, 143360
  s_add_u32 s7, s45, 1083392
  buffer_load_dwordx4 v11, s[12:15], s7 offen lds
  ds_read_b64_tr_b16 v[108:109], v18 offset:40960
  ds_read_b64_tr_b16 v[110:111], v18 offset:41472
  v_mfma_f32_16x16x32_bf16 v[64:67], v[184:187], v[160:163], v[64:67]
  ds_read_b64_tr_b16 v[112:113], v19 offset:40960
  ds_read_b64_tr_b16 v[114:115], v19 offset:41472
  s_waitcnt lgkmcnt(0)
  s_nop 1
  v_mfma_f32_16x16x32_bf16 v[20:23], v[68:71], v[188:191], v[20:23]
  ds_read_b64_tr_b16 v[116:117], v16 offset:12288
  ds_read_b64_tr_b16 v[118:119], v16 offset:12800
  ds_read_b64_tr_b16 v[120:121], v17 offset:12288
  v_mfma_f32_16x16x32_bf16 v[24:27], v[72:75], v[188:191], v[24:27]
  ds_read_b64_tr_b16 v[122:123], v17 offset:12800
  ds_read_b64_tr_b16 v[124:125], v18 offset:12288
  v_mfma_f32_16x16x32_bf16 v[28:31], v[76:79], v[188:191], v[28:31]
  v_lshlrev_b32 v4, 16, v192
  v_and_b32 v5, 0xffff0000, v192
  v_pk_add_f32 v[4:5], v[4:5], v[12:13] op_sel_hi:[1,0]
  v_cvt_pk_bf16_f32 v192, v4, v5
  ds_read_b64_tr_b16 v[126:127], v18 offset:12800
  v_mfma_f32_16x16x32_bf16 v[32:35], v[80:83], v[188:191], v[32:35]
  ds_read_b64_tr_b16 v[128:129], v19 offset:12288
  ds_read_b64_tr_b16 v[130:131], v19 offset:12800
  ds_read_b64_tr_b16 v[132:133], v16 offset:28672
  v_mfma_f32_16x16x32_bf16 v[36:39], v[188:191], v[84:87], v[36:39]
  ds_read_b64_tr_b16 v[134:135], v16 offset:29184
  v_lshlrev_b32 v6, 16, v193
  v_and_b32 v7, 0xffff0000, v193
  v_pk_add_f32 v[6:7], v[6:7], v[12:13] op_sel_hi:[1,0]
  v_cvt_pk_bf16_f32 v193, v6, v7
  v_mfma_f32_16x16x32_bf16 v[40:43], v[188:191], v[88:91], v[40:43]
  ds_read_b64_tr_b16 v[136:137], v17 offset:28672
  ds_read_b64_tr_b16 v[138:139], v17 offset:29184
  v_mfma_f32_16x16x32_bf16 v[44:47], v[188:191], v[92:95], v[44:47]
  ds_read_b64_tr_b16 v[140:141], v18 offset:28672
  ds_read_b64_tr_b16 v[142:143], v18 offset:29184
  ds_read_b64_tr_b16 v[144:145], v19 offset:28672
  v_mfma_f32_16x16x32_bf16 v[48:51], v[188:191], v[96:99], v[48:51]
  v_lshlrev_b32 v8, 16, v194
  v_and_b32 v9, 0xffff0000, v194
  v_pk_add_f32 v[8:9], v[8:9], v[12:13] op_sel_hi:[1,0]
  v_cvt_pk_bf16_f32 v194, v8, v9
  ds_read_b64_tr_b16 v[146:147], v19 offset:29184
  v_mfma_f32_16x16x32_bf16 v[52:55], v[188:191], v[100:103], v[52:55]
  ds_read_b64_tr_b16 v[148:149], v16 offset:45056
  ds_read_b64_tr_b16 v[150:151], v16 offset:45568
  v_mfma_f32_16x16x32_bf16 v[56:59], v[188:191], v[104:107], v[56:59]
  ds_read_b64_tr_b16 v[152:153], v17 offset:45056
  ds_read_b64_tr_b16 v[154:155], v17 offset:45568
  v_lshlrev_b32 v4, 16, v195
  v_and_b32 v5, 0xffff0000, v195
  v_pk_add_f32 v[4:5], v[4:5], v[12:13] op_sel_hi:[1,0]
  v_cvt_pk_bf16_f32 v195, v4, v5
  v_mfma_f32_16x16x32_bf16 v[60:63], v[188:191], v[108:111], v[60:63]
  ds_read_b64_tr_b16 v[156:157], v18 offset:45056
  ds_read_b64_tr_b16 v[158:159], v18 offset:45568
  v_mfma_f32_16x16x32_bf16 v[64:67], v[188:191], v[112:115], v[64:67]
  ds_read_b64_tr_b16 v[160:161], v19 offset:45056
  ds_read_b64_tr_b16 v[162:163], v19 offset:45568
  s_waitcnt vmcnt(0)
  s_barrier
  s_waitcnt lgkmcnt(0)
  s_nop 1
  v_mfma_f32_16x16x32_bf16 v[20:23], v[116:119], v[192:195], v[20:23]
  v_add_u32 v16, 49152, v16
  v_add_u32 v17, 49152, v17
  v_add_u32 v18, 49152, v18
  v_mfma_f32_16x16x32_bf16 v[24:27], v[120:123], v[192:195], v[24:27]
  v_add_u32 v19, 49152, v19
  ds_read_b64_tr_b16 v[68:69], v16 offset:0
  v_lshlrev_b32 v4, 16, v196
  v_and_b32 v5, 0xffff0000, v196
  v_pk_add_f32 v[4:5], v[4:5], v[12:13] op_sel_hi:[1,0]
  v_cvt_pk_bf16_f32 v196, v4, v5
  v_mfma_f32_16x16x32_bf16 v[28:31], v[124:127], v[192:195], v[28:31]
  s_add_u32 m0, s44, 0
  s_add_u32 s7, s45, 1179648
  buffer_load_dwordx4 v11, s[12:15], s7 offen lds
  ds_read_b64_tr_b16 v[70:71], v16 offset:512
  ds_read_b64_tr_b16 v[72:73], v17 offset:0
  v_mfma_f32_16x16x32_bf16 v[32:35], v[128:131], v[192:195], v[32:35]
  ds_read_b64_tr_b16 v[74:75], v17 offset:512
  ds_read_b64_tr_b16 v[76:77], v18 offset:0
  ds_read_b64_tr_b16 v[78:79], v18 offset:512
  v_mfma_f32_16x16x32_bf16 v[36:39], v[192:195], v[132:135], v[36:39]
  v_lshlrev_b32 v6, 16, v197
  v_and_b32 v7, 0xffff0000, v197
  v_pk_add_f32 v[6:7], v[6:7], v[12:13] op_sel_hi:[1,0]
  v_cvt_pk_bf16_f32 v197, v6, v7
  s_add_u32 m0, s44, 16384
  s_add_u32 s7, s45, 1180672
  buffer_load_dwordx4 v11, s[12:15], s7 offen lds
  ds_read_b64_tr_b16 v[80:81], v19 offset:0
  v_mfma_f32_16x16x32_bf16 v[40:43], v[192:195], v[136:139], v[40:43]
  ds_read_b64_tr_b16 v[82:83], v19 offset:512
  ds_read_b64_tr_b16 v[84:85], v16 offset:16384
  ds_read_b64_tr_b16 v[86:87], v16 offset:16896
  v_mfma_f32_16x16x32_bf16 v[44:47], v[192:195], v[140:143], v[44:47]
  ds_read_b64_tr_b16 v[88:89], v17 offset:16384
  v_lshlrev_b32 v8, 16, v198
  v_and_b32 v9, 0xffff0000, v198
  v_pk_add_f32 v[8:9], v[8:9], v[12:13] op_sel_hi:[1,0]
  v_cvt_pk_bf16_f32 v198, v8, v9
  s_add_u32 m0, s44, 32768
  s_add_u32 s7, s45, 1181696
  buffer_load_dwordx4 v11, s[12:15], s7 offen lds
  v_mfma_f32_16x16x32_bf16 v[48:51], v[192:195], v[144:147], v[48:51]
  ds_read_b64_tr_b16 v[90:91], v17 offset:16896
  ds_read_b64_tr_b16 v[92:93], v18 offset:16384
  ds_read_b64_tr_b16 v[94:95], v18 offset:16896
  v_mfma_f32_16x16x32_bf16 v[52:55], v[192:195], v[148:151], v[52:55]
  ds_read_b64_tr_b16 v[96:97], v19 offset:16384
  ds_read_b64_tr_b16 v[98:99], v19 offset:16896
  v_lshlrev_b32 v4, 16, v199
  v_and_b32 v5, 0xffff0000, v199
  v_pk_add_f32 v[4:5], v[4:5], v[12:13] op_sel_hi:[1,0]
  v_cvt_pk_bf16_f32 v199, v4, v5
  v_mfma_f32_16x16x32_bf16 v[56:59], v[192:195], v[152:155], v[56:59]
  s_add_u32 m0, s44, 4096
  s_add_u32 s7, s45, 1277952
  buffer_load_dwordx4 v11, s[12:15], s7 offen lds
  ds_read_b64_tr_b16 v[100:101], v16 offset:32768
  ds_read_b64_tr_b16 v[102:103], v16 offset:33280
  v_mfma_f32_16x16x32_bf16 v[60:63], v[192:195], v[156:159], v[60:63]
  ds_read_b64_tr_b16 v[104:105], v17 offset:32768
  ds_read_b64_tr_b16 v[106:107], v17 offset:33280
  ds_read_b64_tr_b16 v[108:109], v18 offset:32768
  v_mfma_f32_16x16x32_bf16 v[64:67], v[192:195], v[160:163], v[64:67]
  ds_read_b64_tr_b16 v[110:111], v18 offset:33280
  ds_read_b64_tr_b16 v[112:113], v19 offset:32768
  ds_read_b64_tr_b16 v[114:115], v19 offset:33280
  s_waitcnt lgkmcnt(0)
  s_nop 1
  v_mfma_f32_16x16x32_bf16 v[20:23], v[68:71], v[196:199], v[20:23]
  ds_read_b64_tr_b16 v[116:117], v16 offset:4096
  ds_read_b64_tr_b16 v[118:119], v16 offset:4608
  ds_read_b64_tr_b16 v[120:121], v17 offset:4096
  v_mfma_f32_16x16x32_bf16 v[24:27], v[72:75], v[196:199], v[24:27]
  ds_read_b64_tr_b16 v[122:123], v17 offset:4608
  ds_read_b64_tr_b16 v[124:125], v18 offset:4096
  v_lshlrev_b32 v4, 16, v200
  v_and_b32 v5, 0xffff0000, v200
  v_pk_add_f32 v[4:5], v[4:5], v[12:13] op_sel_hi:[1,0]
  v_cvt_pk_bf16_f32 v200, v4, v5
  v_mfma_f32_16x16x32_bf16 v[28:31], v[76:79], v[196:199], v[28:31]
  s_add_u32 m0, s44, 20480
  s_add_u32 s7, s45, 1278976
  buffer_load_dwordx4 v11, s[12:15], s7 offen lds
  ds_read_b64_tr_b16 v[126:127], v18 offset:4608
  v_mfma_f32_16x16x32_bf16 v[32:35], v[80:83], v[196:199], v[32:35]
  ds_read_b64_tr_b16 v[128:129], v19 offset:4096
  ds_read_b64_tr_b16 v[130:131], v19 offset:4608
  ds_read_b64_tr_b16 v[132:133], v16 offset:20480
  v_mfma_f32_16x16x32_bf16 v[36:39], v[196:199], v[84:87], v[36:39]
  ds_read_b64_tr_b16 v[134:135], v16 offset:20992
  v_lshlrev_b32 v6, 16, v201
  v_and_b32 v7, 0xffff0000, v201
  v_pk_add_f32 v[6:7], v[6:7], v[12:13] op_sel_hi:[1,0]
  v_cvt_pk_bf16_f32 v201, v6, v7
  s_add_u32 m0, s44, 36864
  s_add_u32 s7, s45, 1280000
  buffer_load_dwordx4 v11, s[12:15], s7 offen lds
  v_mfma_f32_16x16x32_bf16 v[40:43], v[196:199], v[88:91], v[40:43]
  ds_read_b64_tr_b16 v[136:137], v17 offset:20480
  ds_read_b64_tr_b16 v[138:139], v17 offset:20992
  v_mfma_f32_16x16x32_bf16 v[44:47], v[196:199], v[92:95], v[44:47]
  ds_read_b64_tr_b16 v[140:141], v18 offset:20480
  ds_read_b64_tr_b16 v[142:143], v18 offset:20992
  ds_read_b64_tr_b16 v[144:145], v19 offset:20480
  v_mfma_f32_16x16x32_bf16 v[48:51], v[196:199], v[96:99], v[48:51]
  v_lshlrev_b32 v8, 16, v202
  v_and_b32 v9, 0xffff0000, v202
  v_pk_add_f32 v[8:9], v[8:9], v[12:13] op_sel_hi:[1,0]
  v_cvt_pk_bf16_f32 v202, v8, v9
  s_add_u32 m0, s44, 8192
  s_add_u32 s7, s45, 1376256
  buffer_load_dwordx4 v11, s[12:15], s7 offen lds
  ds_read_b64_tr_b16 v[146:147], v19 offset:20992
  v_mfma_f32_16x16x32_bf16 v[52:55], v[196:199], v[100:103], v[52:55]
  ds_read_b64_tr_b16 v[148:149], v16 offset:36864
  ds_read_b64_tr_b16 v[150:151], v16 offset:37376
  v_mfma_f32_16x16x32_bf16 v[56:59], v[196:199], v[104:107], v[56:59]
  ds_read_b64_tr_b16 v[152:153], v17 offset:36864
  ds_read_b64_tr_b16 v[154:155], v17 offset:37376
  v_lshlrev_b32 v4, 16, v203
  v_and_b32 v5, 0xffff0000, v203
  v_pk_add_f32 v[4:5], v[4:5], v[12:13] op_sel_hi:[1,0]
  v_cvt_pk_bf16_f32 v203, v4, v5
  v_mfma_f32_16x16x32_bf16 v[60:63], v[196:199], v[108:111], v[60:63]
  s_add_u32 m0, s44, 24576
  s_add_u32 s7, s45, 1377280
  buffer_load_dwordx4 v11, s[12:15], s7 offen lds
  ds_read_b64_tr_b16 v[156:157], v18 offset:36864
  ds_read_b64_tr_b16 v[158:159], v18 offset:37376
  v_mfma_f32_16x16x32_bf16 v[64:67], v[196:199], v[112:115], v[64:67]
  ds_read_b64_tr_b16 v[160:161], v19 offset:36864
  ds_read_b64_tr_b16 v[162:163], v19 offset:37376
  s_waitcnt lgkmcnt(0)
  s_nop 1
  v_mfma_f32_16x16x32_bf16 v[20:23], v[116:119], v[200:203], v[20:23]
  ds_read_b64_tr_b16 v[68:69], v16 offset:8192
  ds_read_b64_tr_b16 v[70:71], v16 offset:8704
  ds_read_b64_tr_b16 v[72:73], v17 offset:8192
  v_mfma_f32_16x16x32_bf16 v[24:27], v[120:123], v[200:203], v[24:27]
  ds_read_b64_tr_b16 v[74:75], v17 offset:8704
  ds_read_b64_tr_b16 v[76:77], v18 offset:8192
  v_lshlrev_b32 v4, 16, v204
  v_and_b32 v5, 0xffff0000, v204
  v_pk_add_f32 v[4:5], v[4:5], v[12:13] op_sel_hi:[1,0]
  v_cvt_pk_bf16_f32 v204, v4, v5
  v_mfma_f32_16x16x32_bf16 v[28:31], v[124:127], v[200:203], v[28:31]
  s_add_u32 m0, s44, 40960
  s_add_u32 s7, s45, 1378304
  buffer_load_dwordx4 v11, s[12:15], s7 offen lds
  ds_read_b64_tr_b16 v[78:79], v18 offset:8704
  v_mfma_f32_16x16x32_bf16 v[32:35], v[128:131], v[200:203], v[32:35]
  ds_read_b64_tr_b16 v[80:81], v19 offset:8192
  ds_read_b64_tr_b16 v[82:83], v19 offset:8704
  ds_read_b64_tr_b16 v[84:85], v16 offset:24576
  v_mfma_f32_16x16x32_bf16 v[36:39], v[200:203], v[132:135], v[36:39]
  ds_read_b64_tr_b16 v[86:87], v16 offset:25088
  v_lshlrev_b32 v6, 16, v205
  v_and_b32 v7, 0xffff0000, v205
  v_pk_add_f32 v[6:7], v[6:7], v[12:13] op_sel_hi:[1,0]
  v_cvt_pk_bf16_f32 v205, v6, v7
  s_add_u32 m0, s44, 12288
  s_add_u32 s7, s45, 1474560
  buffer_load_dwordx4 v11, s[12:15], s7 offen lds
  v_mfma_f32_16x16x32_bf16 v[40:43], v[200:203], v[136:139], v[40:43]
  ds_read_b64_tr_b16 v[88:89], v17 offset:24576
  ds_read_b64_tr_b16 v[90:91], v17 offset:25088
  v_mfma_f32_16x16x32_bf16 v[44:47], v[200:203], v[140:143], v[44:47]
  ds_read_b64_tr_b16 v[92:93], v18 offset:24576
  ds_read_b64_tr_b16 v[94:95], v18 offset:25088
  ds_read_b64_tr_b16 v[96:97], v19 offset:24576
  v_mfma_f32_16x16x32_bf16 v[48:51], v[200:203], v[144:147], v[48:51]
  v_lshlrev_b32 v8, 16, v206
  v_and_b32 v9, 0xffff0000, v206
  v_pk_add_f32 v[8:9], v[8:9], v[12:13] op_sel_hi:[1,0]
  v_cvt_pk_bf16_f32 v206, v8, v9
  s_add_u32 m0, s44, 28672
  s_add_u32 s7, s45, 1475584
  buffer_load_dwordx4 v11, s[12:15], s7 offen lds
  ds_read_b64_tr_b16 v[98:99], v19 offset:25088
  v_mfma_f32_16x16x32_bf16 v[52:55], v[200:203], v[148:151], v[52:55]
  ds_read_b64_tr_b16 v[100:101], v16 offset:40960
  ds_read_b64_tr_b16 v[102:103], v16 offset:41472
  v_mfma_f32_16x16x32_bf16 v[56:59], v[200:203], v[152:155], v[56:59]
  ds_read_b64_tr_b16 v[104:105], v17 offset:40960
  ds_read_b64_tr_b16 v[106:107], v17 offset:41472
  v_lshlrev_b32 v4, 16, v207
  v_and_b32 v5, 0xffff0000, v207
  v_pk_add_f32 v[4:5], v[4:5], v[12:13] op_sel_hi:[1,0]
  v_cvt_pk_bf16_f32 v207, v4, v5
  v_mfma_f32_16x16x32_bf16 v[60:63], v[200:203], v[156:159], v[60:63]
  s_add_u32 m0, s44, 45056
  s_add_u32 s7, s45, 1476608
  buffer_load_dwordx4 v11, s[12:15], s7 offen lds
  ds_read_b64_tr_b16 v[108:109], v18 offset:40960
  ds_read_b64_tr_b16 v[110:111], v18 offset:41472
  v_mfma_f32_16x16x32_bf16 v[64:67], v[200:203], v[160:163], v[64:67]
  ds_read_b64_tr_b16 v[112:113], v19 offset:40960
  ds_read_b64_tr_b16 v[114:115], v19 offset:41472
  s_waitcnt lgkmcnt(0)
  s_nop 1
  v_mfma_f32_16x16x32_bf16 v[20:23], v[68:71], v[204:207], v[20:23]
  ds_read_b64_tr_b16 v[116:117], v16 offset:12288
  ds_read_b64_tr_b16 v[118:119], v16 offset:12800
  ds_read_b64_tr_b16 v[120:121], v17 offset:12288
  v_mfma_f32_16x16x32_bf16 v[24:27], v[72:75], v[204:207], v[24:27]
  ds_read_b64_tr_b16 v[122:123], v17 offset:12800
  ds_read_b64_tr_b16 v[124:125], v18 offset:12288
  v_mfma_f32_16x16x32_bf16 v[28:31], v[76:79], v[204:207], v[28:31]
  v_lshlrev_b32 v4, 16, v208
  v_and_b32 v5, 0xffff0000, v208
  v_pk_add_f32 v[4:5], v[4:5], v[12:13] op_sel_hi:[1,0]
  v_cvt_pk_bf16_f32 v208, v4, v5
  ds_read_b64_tr_b16 v[126:127], v18 offset:12800
  v_mfma_f32_16x16x32_bf16 v[32:35], v[80:83], v[204:207], v[32:35]
  ds_read_b64_tr_b16 v[128:129], v19 offset:12288
  ds_read_b64_tr_b16 v[130:131], v19 offset:12800
  ds_read_b64_tr_b16 v[132:133], v16 offset:28672
  v_mfma_f32_16x16x32_bf16 v[36:39], v[204:207], v[84:87], v[36:39]
  ds_read_b64_tr_b16 v[134:135], v16 offset:29184
  v_lshlrev_b32 v6, 16, v209
  v_and_b32 v7, 0xffff0000, v209
  v_pk_add_f32 v[6:7], v[6:7], v[12:13] op_sel_hi:[1,0]
  v_cvt_pk_bf16_f32 v209, v6, v7
  v_mfma_f32_16x16x32_bf16 v[40:43], v[204:207], v[88:91], v[40:43]
  ds_read_b64_tr_b16 v[136:137], v17 offset:28672
  ds_read_b64_tr_b16 v[138:139], v17 offset:29184
  v_mfma_f32_16x16x32_bf16 v[44:47], v[204:207], v[92:95], v[44:47]
  ds_read_b64_tr_b16 v[140:141], v18 offset:28672
  ds_read_b64_tr_b16 v[142:143], v18 offset:29184
  ds_read_b64_tr_b16 v[144:145], v19 offset:28672
  v_mfma_f32_16x16x32_bf16 v[48:51], v[204:207], v[96:99], v[48:51]
  v_lshlrev_b32 v8, 16, v210
  v_and_b32 v9, 0xffff0000, v210
  v_pk_add_f32 v[8:9], v[8:9], v[12:13] op_sel_hi:[1,0]
  v_cvt_pk_bf16_f32 v210, v8, v9
  ds_read_b64_tr_b16 v[146:147], v19 offset:29184
  v_mfma_f32_16x16x32_bf16 v[52:55], v[204:207], v[100:103], v[52:55]
  ds_read_b64_tr_b16 v[148:149], v16 offset:45056
  ds_read_b64_tr_b16 v[150:151], v16 offset:45568
  v_mfma_f32_16x16x32_bf16 v[56:59], v[204:207], v[104:107], v[56:59]
  ds_read_b64_tr_b16 v[152:153], v17 offset:45056
  ds_read_b64_tr_b16 v[154:155], v17 offset:45568
  v_lshlrev_b32 v4, 16, v211
  v_and_b32 v5, 0xffff0000, v211
  v_pk_add_f32 v[4:5], v[4:5], v[12:13] op_sel_hi:[1,0]
  v_cvt_pk_bf16_f32 v211, v4, v5
  v_mfma_f32_16x16x32_bf16 v[60:63], v[204:207], v[108:111], v[60:63]
  ds_read_b64_tr_b16 v[156:157], v18 offset:45056
  ds_read_b64_tr_b16 v[158:159], v18 offset:45568
  v_mfma_f32_16x16x32_bf16 v[64:67], v[204:207], v[112:115], v[64:67]
  ds_read_b64_tr_b16 v[160:161], v19 offset:45056
  ds_read_b64_tr_b16 v[162:163], v19 offset:45568
  s_waitcnt vmcnt(0)
  s_barrier
  s_waitcnt lgkmcnt(0)
  s_nop 1
  v_mfma_f32_16x16x32_bf16 v[20:23], v[116:119], v[208:211], v[20:23]
  v_add_u32 v16, -98304, v16
  v_add_u32 v17, -98304, v17
  v_add_u32 v18, -98304, v18
  v_mfma_f32_16x16x32_bf16 v[24:27], v[120:123], v[208:211], v[24:27]
  v_add_u32 v19, -98304, v19
  ds_read_b64_tr_b16 v[68:69], v16 offset:0
  v_lshlrev_b32 v4, 16, v212
  v_and_b32 v5, 0xffff0000, v212
  v_pk_add_f32 v[4:5], v[4:5], v[12:13] op_sel_hi:[1,0]
  v_cvt_pk_bf16_f32 v212, v4, v5
  v_mfma_f32_16x16x32_bf16 v[28:31], v[124:127], v[208:211], v[28:31]
  ds_read_b64_tr_b16 v[70:71], v16 offset:512
  ds_read_b64_tr_b16 v[72:73], v17 offset:0
  v_mfma_f32_16x16x32_bf16 v[32:35], v[128:131], v[208:211], v[32:35]
  ds_read_b64_tr_b16 v[74:75], v17 offset:512
  ds_read_b64_tr_b16 v[76:77], v18 offset:0
  ds_read_b64_tr_b16 v[78:79], v18 offset:512
  v_mfma_f32_16x16x32_bf16 v[36:39], v[208:211], v[132:135], v[36:39]
  v_lshlrev_b32 v6, 16, v213
  v_and_b32 v7, 0xffff0000, v213
  v_pk_add_f32 v[6:7], v[6:7], v[12:13] op_sel_hi:[1,0]
  v_cvt_pk_bf16_f32 v213, v6, v7
  ds_read_b64_tr_b16 v[80:81], v19 offset:0
  ds_read_b64_tr_b16 v[82:83], v19 offset:512
  v_mfma_f32_16x16x32_bf16 v[40:43], v[208:211], v[136:139], v[40:43]
  ds_read_b64_tr_b16 v[84:85], v16 offset:16384
  ds_read_b64_tr_b16 v[86:87], v16 offset:16896
  v_mfma_f32_16x16x32_bf16 v[44:47], v[208:211], v[140:143], v[44:47]
  ds_read_b64_tr_b16 v[88:89], v17 offset:16384
  v_lshlrev_b32 v8, 16, v214
  v_and_b32 v9, 0xffff0000, v214
  v_pk_add_f32 v[8:9], v[8:9], v[12:13] op_sel_hi:[1,0]
  v_cvt_pk_bf16_f32 v214, v8, v9
  ds_read_b64_tr_b16 v[90:91], v17 offset:16896
  v_mfma_f32_16x16x32_bf16 v[48:51], v[208:211], v[144:147], v[48:51]
  ds_read_b64_tr_b16 v[92:93], v18 offset:16384
  ds_read_b64_tr_b16 v[94:95], v18 offset:16896
  ds_read_b64_tr_b16 v[96:97], v19 offset:16384
  v_mfma_f32_16x16x32_bf16 v[52:55], v[208:211], v[148:151], v[52:55]
  ds_read_b64_tr_b16 v[98:99], v19 offset:16896
  v_lshlrev_b32 v4, 16, v215
  v_and_b32 v5, 0xffff0000, v215
  v_pk_add_f32 v[4:5], v[4:5], v[12:13] op_sel_hi:[1,0]
  v_cvt_pk_bf16_f32 v215, v4, v5
  v_mfma_f32_16x16x32_bf16 v[56:59], v[208:211], v[152:155], v[56:59]
  ds_read_b64_tr_b16 v[100:101], v16 offset:32768
  ds_read_b64_tr_b16 v[102:103], v16 offset:33280
  ds_read_b64_tr_b16 v[104:105], v17 offset:32768
  v_mfma_f32_16x16x32_bf16 v[60:63], v[208:211], v[156:159], v[60:63]
  ds_read_b64_tr_b16 v[106:107], v17 offset:33280
  ds_read_b64_tr_b16 v[108:109], v18 offset:32768
  ds_read_b64_tr_b16 v[110:111], v18 offset:33280
  v_mfma_f32_16x16x32_bf16 v[64:67], v[208:211], v[160:163], v[64:67]
  ds_read_b64_tr_b16 v[112:113], v19 offset:32768
  ds_read_b64_tr_b16 v[114:115], v19 offset:33280
  s_waitcnt lgkmcnt(0)
  s_nop 1
  v_mfma_f32_16x16x32_bf16 v[20:23], v[68:71], v[212:215], v[20:23]
  ds_read_b64_tr_b16 v[116:117], v16 offset:4096
  ds_read_b64_tr_b16 v[118:119], v16 offset:4608
  ds_read_b64_tr_b16 v[120:121], v17 offset:4096
  v_mfma_f32_16x16x32_bf16 v[24:27], v[72:75], v[212:215], v[24:27]
  ds_read_b64_tr_b16 v[122:123], v17 offset:4608
  ds_read_b64_tr_b16 v[124:125], v18 offset:4096
  v_mfma_f32_16x16x32_bf16 v[28:31], v[76:79], v[212:215], v[28:31]
  v_lshlrev_b32 v4, 16, v216
  v_and_b32 v5, 0xffff0000, v216
  v_pk_add_f32 v[4:5], v[4:5], v[12:13] op_sel_hi:[1,0]
  v_cvt_pk_bf16_f32 v216, v4, v5
  ds_read_b64_tr_b16 v[126:127], v18 offset:4608
  v_mfma_f32_16x16x32_bf16 v[32:35], v[80:83], v[212:215], v[32:35]
  ds_read_b64_tr_b16 v[128:129], v19 offset:4096
  ds_read_b64_tr_b16 v[130:131], v19 offset:4608
  ds_read_b64_tr_b16 v[132:133], v16 offset:20480
  v_mfma_f32_16x16x32_bf16 v[36:39], v[212:215], v[84:87], v[36:39]
  ds_read_b64_tr_b16 v[134:135], v16 offset:20992
  v_lshlrev_b32 v6, 16, v217
  v_and_b32 v7, 0xffff0000, v217
  v_pk_add_f32 v[6:7], v[6:7], v[12:13] op_sel_hi:[1,0]
  v_cvt_pk_bf16_f32 v217, v6, v7
  v_mfma_f32_16x16x32_bf16 v[40:43], v[212:215], v[88:91], v[40:43]
  ds_read_b64_tr_b16 v[136:137], v17 offset:20480
  ds_read_b64_tr_b16 v[138:139], v17 offset:20992
  v_mfma_f32_16x16x32_bf16 v[44:47], v[212:215], v[92:95], v[44:47]
  ds_read_b64_tr_b16 v[140:141], v18 offset:20480
  ds_read_b64_tr_b16 v[142:143], v18 offset:20992
  ds_read_b64_tr_b16 v[144:145], v19 offset:20480
  v_mfma_f32_16x16x32_bf16 v[48:51], v[212:215], v[96:99], v[48:51]
  v_lshlrev_b32 v8, 16, v218
  v_and_b32 v9, 0xffff0000, v218
  v_pk_add_f32 v[8:9], v[8:9], v[12:13] op_sel_hi:[1,0]
  v_cvt_pk_bf16_f32 v218, v8, v9
  ds_read_b64_tr_b16 v[146:147], v19 offset:20992
  v_mfma_f32_16x16x32_bf16 v[52:55], v[212:215], v[100:103], v[52:55]
  ds_read_b64_tr_b16 v[148:149], v16 offset:36864
  ds_read_b64_tr_b16 v[150:151], v16 offset:37376
  v_mfma_f32_16x16x32_bf16 v[56:59], v[212:215], v[104:107], v[56:59]
  ds_read_b64_tr_b16 v[152:153], v17 offset:36864
  ds_read_b64_tr_b16 v[154:155], v17 offset:37376
  v_lshlrev_b32 v4, 16, v219
  v_and_b32 v5, 0xffff0000, v219
  v_pk_add_f32 v[4:5], v[4:5], v[12:13] op_sel_hi:[1,0]
  v_cvt_pk_bf16_f32 v219, v4, v5
  v_mfma_f32_16x16x32_bf16 v[60:63], v[212:215], v[108:111], v[60:63]
  ds_read_b64_tr_b16 v[156:157], v18 offset:36864
  ds_read_b64_tr_b16 v[158:159], v18 offset:37376
  v_mfma_f32_16x16x32_bf16 v[64:67], v[212:215], v[112:115], v[64:67]
  ds_read_b64_tr_b16 v[160:161], v19 offset:36864
  ds_read_b64_tr_b16 v[162:163], v19 offset:37376
  s_waitcnt lgkmcnt(0)
  s_nop 1
  v_mfma_f32_16x16x32_bf16 v[20:23], v[116:119], v[216:219], v[20:23]
  ds_read_b64_tr_b16 v[68:69], v16 offset:8192
  ds_read_b64_tr_b16 v[70:71], v16 offset:8704
  ds_read_b64_tr_b16 v[72:73], v17 offset:8192
  v_mfma_f32_16x16x32_bf16 v[24:27], v[120:123], v[216:219], v[24:27]
  ds_read_b64_tr_b16 v[74:75], v17 offset:8704
  ds_read_b64_tr_b16 v[76:77], v18 offset:8192
  v_mfma_f32_16x16x32_bf16 v[28:31], v[124:127], v[216:219], v[28:31]
  v_lshlrev_b32 v4, 16, v220
  v_and_b32 v5, 0xffff0000, v220
  v_pk_add_f32 v[4:5], v[4:5], v[12:13] op_sel_hi:[1,0]
  v_cvt_pk_bf16_f32 v220, v4, v5
  ds_read_b64_tr_b16 v[78:79], v18 offset:8704
  v_mfma_f32_16x16x32_bf16 v[32:35], v[128:131], v[216:219], v[32:35]
  ds_read_b64_tr_b16 v[80:81], v19 offset:8192
  ds_read_b64_tr_b16 v[82:83], v19 offset:8704
  ds_read_b64_tr_b16 v[84:85], v16 offset:24576
  v_mfma_f32_16x16x32_bf16 v[36:39], v[216:219], v[132:135], v[36:39]
  ds_read_b64_tr_b16 v[86:87], v16 offset:25088
  v_lshlrev_b32 v6, 16, v221
  v_and_b32 v7, 0xffff0000, v221
  v_pk_add_f32 v[6:7], v[6:7], v[12:13] op_sel_hi:[1,0]
  v_cvt_pk_bf16_f32 v221, v6, v7
  v_mfma_f32_16x16x32_bf16 v[40:43], v[216:219], v[136:139], v[40:43]
  ds_read_b64_tr_b16 v[88:89], v17 offset:24576
  ds_read_b64_tr_b16 v[90:91], v17 offset:25088
  v_mfma_f32_16x16x32_bf16 v[44:47], v[216:219], v[140:143], v[44:47]
  ds_read_b64_tr_b16 v[92:93], v18 offset:24576
  ds_read_b64_tr_b16 v[94:95], v18 offset:25088
  ds_read_b64_tr_b16 v[96:97], v19 offset:24576
  v_mfma_f32_16x16x32_bf16 v[48:51], v[216:219], v[144:147], v[48:51]
  v_lshlrev_b32 v8, 16, v222
  v_and_b32 v9, 0xffff0000, v222
  v_pk_add_f32 v[8:9], v[8:9], v[12:13] op_sel_hi:[1,0]
  v_cvt_pk_bf16_f32 v222, v8, v9
  ds_read_b64_tr_b16 v[98:99], v19 offset:25088
  v_mfma_f32_16x16x32_bf16 v[52:55], v[216:219], v[148:151], v[52:55]
  ds_read_b64_tr_b16 v[100:101], v16 offset:40960
  ds_read_b64_tr_b16 v[102:103], v16 offset:41472
  v_mfma_f32_16x16x32_bf16 v[56:59], v[216:219], v[152:155], v[56:59]
  ds_read_b64_tr_b16 v[104:105], v17 offset:40960
  ds_read_b64_tr_b16 v[106:107], v17 offset:41472
  v_lshlrev_b32 v4, 16, v223
  v_and_b32 v5, 0xffff0000, v223
  v_pk_add_f32 v[4:5], v[4:5], v[12:13] op_sel_hi:[1,0]
  v_cvt_pk_bf16_f32 v223, v4, v5
  v_mfma_f32_16x16x32_bf16 v[60:63], v[216:219], v[156:159], v[60:63]
  ds_read_b64_tr_b16 v[108:109], v18 offset:40960
  ds_read_b64_tr_b16 v[110:111], v18 offset:41472
  v_mfma_f32_16x16x32_bf16 v[64:67], v[216:219], v[160:163], v[64:67]
  ds_read_b64_tr_b16 v[112:113], v19 offset:40960
  ds_read_b64_tr_b16 v[114:115], v19 offset:41472
  s_waitcnt lgkmcnt(0)
  s_nop 1
  v_mfma_f32_16x16x32_bf16 v[20:23], v[68:71], v[220:223], v[20:23]
  ds_read_b64_tr_b16 v[116:117], v16 offset:12288
  ds_read_b64_tr_b16 v[118:119], v16 offset:12800
  ds_read_b64_tr_b16 v[120:121], v17 offset:12288
  v_mfma_f32_16x16x32_bf16 v[24:27], v[72:75], v[220:223], v[24:27]
  ds_read_b64_tr_b16 v[122:123], v17 offset:12800
  ds_read_b64_tr_b16 v[124:125], v18 offset:12288
  v_mfma_f32_16x16x32_bf16 v[28:31], v[76:79], v[220:223], v[28:31]
  v_lshlrev_b32 v4, 16, v224
  v_and_b32 v5, 0xffff0000, v224
  v_pk_add_f32 v[4:5], v[4:5], v[12:13] op_sel_hi:[1,0]
  v_cvt_pk_bf16_f32 v224, v4, v5
  ds_read_b64_tr_b16 v[126:127], v18 offset:12800
  v_mfma_f32_16x16x32_bf16 v[32:35], v[80:83], v[220:223], v[32:35]
  ds_read_b64_tr_b16 v[128:129], v19 offset:12288
  ds_read_b64_tr_b16 v[130:131], v19 offset:12800
  ds_read_b64_tr_b16 v[132:133], v16 offset:28672
  v_mfma_f32_16x16x32_bf16 v[36:39], v[220:223], v[84:87], v[36:39]
  ds_read_b64_tr_b16 v[134:135], v16 offset:29184
  v_lshlrev_b32 v6, 16, v225
  v_and_b32 v7, 0xffff0000, v225
  v_pk_add_f32 v[6:7], v[6:7], v[12:13] op_sel_hi:[1,0]
  v_cvt_pk_bf16_f32 v225, v6, v7
  v_mfma_f32_16x16x32_bf16 v[40:43], v[220:223], v[88:91], v[40:43]
  ds_read_b64_tr_b16 v[136:137], v17 offset:28672
  ds_read_b64_tr_b16 v[138:139], v17 offset:29184
  v_mfma_f32_16x16x32_bf16 v[44:47], v[220:223], v[92:95], v[44:47]
  ds_read_b64_tr_b16 v[140:141], v18 offset:28672
  ds_read_b64_tr_b16 v[142:143], v18 offset:29184
  ds_read_b64_tr_b16 v[144:145], v19 offset:28672
  v_mfma_f32_16x16x32_bf16 v[48:51], v[220:223], v[96:99], v[48:51]
  v_lshlrev_b32 v8, 16, v226
  v_and_b32 v9, 0xffff0000, v226
  v_pk_add_f32 v[8:9], v[8:9], v[12:13] op_sel_hi:[1,0]
  v_cvt_pk_bf16_f32 v226, v8, v9
  ds_read_b64_tr_b16 v[146:147], v19 offset:29184
  v_mfma_f32_16x16x32_bf16 v[52:55], v[220:223], v[100:103], v[52:55]
  ds_read_b64_tr_b16 v[148:149], v16 offset:45056
  ds_read_b64_tr_b16 v[150:151], v16 offset:45568
  v_mfma_f32_16x16x32_bf16 v[56:59], v[220:223], v[104:107], v[56:59]
  ds_read_b64_tr_b16 v[152:153], v17 offset:45056
  ds_read_b64_tr_b16 v[154:155], v17 offset:45568
  v_lshlrev_b32 v4, 16, v227
  v_and_b32 v5, 0xffff0000, v227
  v_pk_add_f32 v[4:5], v[4:5], v[12:13] op_sel_hi:[1,0]
  v_cvt_pk_bf16_f32 v227, v4, v5
  v_mfma_f32_16x16x32_bf16 v[60:63], v[220:223], v[108:111], v[60:63]
  ds_read_b64_tr_b16 v[156:157], v18 offset:45056
  ds_read_b64_tr_b16 v[158:159], v18 offset:45568
  v_mfma_f32_16x16x32_bf16 v[64:67], v[220:223], v[112:115], v[64:67]
  ds_read_b64_tr_b16 v[160:161], v19 offset:45056
  ds_read_b64_tr_b16 v[162:163], v19 offset:45568
  s_waitcnt lgkmcnt(0)
  s_nop 1
  v_mfma_f32_16x16x32_bf16 v[20:23], v[116:119], v[224:227], v[20:23]
  v_mfma_f32_16x16x32_bf16 v[24:27], v[120:123], v[224:227], v[24:27]
  v_mfma_f32_16x16x32_bf16 v[28:31], v[124:127], v[224:227], v[28:31]
  v_mfma_f32_16x16x32_bf16 v[32:35], v[128:131], v[224:227], v[32:35]
  v_mfma_f32_16x16x32_bf16 v[36:39], v[224:227], v[132:135], v[36:39]
  v_mfma_f32_16x16x32_bf16 v[40:43], v[224:227], v[136:139], v[40:43]
  v_mfma_f32_16x16x32_bf16 v[44:47], v[224:227], v[140:143], v[44:47]
  v_mfma_f32_16x16x32_bf16 v[48:51], v[224:227], v[144:147], v[48:51]
  v_mfma_f32_16x16x32_bf16 v[52:55], v[224:227], v[148:151], v[52:55]
  v_mfma_f32_16x16x32_bf16 v[56:59], v[224:227], v[152:155], v[56:59]
  v_mfma_f32_16x16x32_bf16 v[60:63], v[224:227], v[156:159], v[60:63]
  v_mfma_f32_16x16x32_bf16 v[64:67], v[224:227], v[160:163], v[64:67]
  s_cmp_lg_u32 s5, 0
  s_cbranch_scc1 k1_kernel_nopf
  s_load_dwordx2 s[52:53], s[0:1], 16
  s_load_dwordx2 s[54:55], s[0:1], 32
  s_lshr_b32 s50, s2, 3
  s_and_b32 s51, s2, 1
  s_waitcnt lgkmcnt(0)
  s_mov_b32 s56, s52
  s_mov_b32 s57, s53
  s_mov_b32 s58, 524288
  s_mov_b32 s59, 0x00020000
  s_lshl_b32 s6, s50, 14
  s_lshl_b32 s7, s51, 9
  s_add_u32 s6, s6, s7
  v_lshrrev_b32 v244, 3, v0
  v_and_b32 v244, 7, v244
  s_mov_b32 s49, 1024
  v_mul_lo_u32 v244, s49, v244
  v_and_b32 v245, 7, v0
  v_lshl_add_u32 v244, v245, 6, v244
  s_add_u32 s49, s6, 0
  buffer_load_dword v245, v244, s[56:59], s49 offen
  s_add_u32 s49, s6, 8192
  buffer_load_dword v245, v244, s[56:59], s49 offen
  s_mov_b32 s56, s54
  s_mov_b32 s57, s55
  s_mov_b32 s58, 1835008
  s_mov_b32 s59, 0x00020000
  s_mul_i32 s6, s50, 57344
  s_mul_i32 s7, s51, 1792
  s_add_u32 s6, s6, s7
  v_lshrrev_b32 v244, 5, v0
  v_and_b32 v244, 1, v244
  s_mov_b32 s49, 3584
  v_mul_lo_u32 v244, s49, v244
  v_and_b32 v245, 31, v0
  v_lshl_add_u32 v244, v245, 6, v244
  s_add_u32 s49, s6, 0
  buffer_load_dword v245, v244, s[56:59], s49 offen
  s_add_u32 s49, s6, 7168
  buffer_load_dword v245, v244, s[56:59], s49 offen
  s_add_u32 s49, s6, 14336
  buffer_load_dword v245, v244, s[56:59], s49 offen
  s_add_u32 s49, s6, 21504
  buffer_load_dword v245, v244, s[56:59], s49 offen
  s_add_u32 s49, s6, 28672
  buffer_load_dword v245, v244, s[56:59], s49 offen
  s_add_u32 s49, s6, 35840
  buffer_load_dword v245, v244, s[56:59], s49 offen
  s_add_u32 s49, s6, 43008
  buffer_load_dword v245, v244, s[56:59], s49 offen
  s_add_u32 s49, s6, 50176
  buffer_load_dword v245, v244, s[56:59], s49 offen
k1_kernel_nopf:
  v_mov_b32 v165, s4
  v_lshlrev_b32 v165, 2, v165
  buffer_load_dword v164, v165, s[20:23], 0 offen sc0 sc1
  v_lshlrev_b32 v166, 4, v2
  v_lshlrev_b32 v167, 4, v2
  v_add_u32 v167, 4, v167
  v_lshlrev_b32 v168, 4, v2
  v_add_u32 v168, 8, v168
  v_lshlrev_b32 v169, 4, v2
  v_add_u32 v169, 12, v169
  ds_bpermute_b32 v170, v166, v14
  ds_bpermute_b32 v171, v167, v14
  ds_bpermute_b32 v172, v168, v14
  ds_bpermute_b32 v173, v169, v14
  s_nop 4
  v_mul_f32 v20, v14, v20
  v_min_f32 v174, 0, v20
  v_mul_f32 v174, 0x3fb8aa3b, v174
  v_exp_f32 v174, v174
  v_max_f32 v20, 0, v20
  v_add_f32 v20, 0x358637bd, v20
  v_add_f32 v20, v20, v174
  v_mul_f32 v21, v14, v21
  v_min_f32 v174, 0, v21
  v_mul_f32 v174, 0x3fb8aa3b, v174
  v_exp_f32 v174, v174
  v_max_f32 v21, 0, v21
  v_add_f32 v21, 0x358637bd, v21
  v_add_f32 v21, v21, v174
  v_mul_f32 v22, v14, v22
  v_min_f32 v174, 0, v22
  v_mul_f32 v174, 0x3fb8aa3b, v174
  v_exp_f32 v174, v174
  v_max_f32 v22, 0, v22
  v_add_f32 v22, 0x358637bd, v22
  v_add_f32 v22, v22, v174
  v_mul_f32 v23, v14, v23
  v_min_f32 v174, 0, v23
  v_mul_f32 v174, 0x3fb8aa3b, v174
  v_exp_f32 v174, v174
  v_max_f32 v23, 0, v23
  v_add_f32 v23, 0x358637bd, v23
  v_add_f32 v23, v23, v174
  v_cvt_pk_bf16_f32 v176, v20, v21
  v_cvt_pk_bf16_f32 v177, v22, v23
  v_mul_f32 v24, v14, v24
  v_min_f32 v174, 0, v24
  v_mul_f32 v174, 0x3fb8aa3b, v174
  v_exp_f32 v174, v174
  v_max_f32 v24, 0, v24
  v_add_f32 v24, 0x358637bd, v24
  v_add_f32 v24, v24, v174
  v_mul_f32 v25, v14, v25
  v_min_f32 v174, 0, v25
  v_mul_f32 v174, 0x3fb8aa3b, v174
  v_exp_f32 v174, v174
  v_max_f32 v25, 0, v25
  v_add_f32 v25, 0x358637bd, v25
  v_add_f32 v25, v25, v174
  v_mul_f32 v26, v14, v26
  v_min_f32 v174, 0, v26
  v_mul_f32 v174, 0x3fb8aa3b, v174
  v_exp_f32 v174, v174
  v_max_f32 v26, 0, v26
  v_add_f32 v26, 0x358637bd, v26
  v_add_f32 v26, v26, v174
  v_mul_f32 v27, v14, v27
  v_min_f32 v174, 0, v27
  v_mul_f32 v174, 0x3fb8aa3b, v174
  v_exp_f32 v174, v174
  v_max_f32 v27, 0, v27
  v_add_f32 v27, 0x358637bd, v27
  v_add_f32 v27, v27, v174
  v_cvt_pk_bf16_f32 v178, v24, v25
  v_cvt_pk_bf16_f32 v179, v26, v27
  v_mul_f32 v28, v14, v28
  v_min_f32 v174, 0, v28
  v_mul_f32 v174, 0x3fb8aa3b, v174
  v_exp_f32 v174, v174
  v_max_f32 v28, 0, v28
  v_add_f32 v28, 0x358637bd, v28
  v_add_f32 v28, v28, v174
  v_mul_f32 v29, v14, v29
  v_min_f32 v174, 0, v29
  v_mul_f32 v174, 0x3fb8aa3b, v174
  v_exp_f32 v174, v174
  v_max_f32 v29, 0, v29
  v_add_f32 v29, 0x358637bd, v29
  v_add_f32 v29, v29, v174
  v_mul_f32 v30, v14, v30
  v_min_f32 v174, 0, v30
  v_mul_f32 v174, 0x3fb8aa3b, v174
  v_exp_f32 v174, v174
  v_max_f32 v30, 0, v30
  v_add_f32 v30, 0x358637bd, v30
  v_add_f32 v30, v30, v174
  v_mul_f32 v31, v14, v31
  v_min_f32 v174, 0, v31
  v_mul_f32 v174, 0x3fb8aa3b, v174
  v_exp_f32 v174, v174
  v_max_f32 v31, 0, v31
  v_add_f32 v31, 0x358637bd, v31
  v_add_f32 v31, v31, v174
  v_cvt_pk_bf16_f32 v180, v28, v29
  v_cvt_pk_bf16_f32 v181, v30, v31
  v_mul_f32 v32, v14, v32
  v_min_f32 v174, 0, v32
  v_mul_f32 v174, 0x3fb8aa3b, v174
  v_exp_f32 v174, v174
  v_max_f32 v32, 0, v32
  v_add_f32 v32, 0x358637bd, v32
  v_add_f32 v32, v32, v174
  v_mul_f32 v33, v14, v33
  v_min_f32 v174, 0, v33
  v_mul_f32 v174, 0x3fb8aa3b, v174
  v_exp_f32 v174, v174
  v_max_f32 v33, 0, v33
  v_add_f32 v33, 0x358637bd, v33
  v_add_f32 v33, v33, v174
  v_mul_f32 v34, v14, v34
  v_min_f32 v174, 0, v34
  v_mul_f32 v174, 0x3fb8aa3b, v174
  v_exp_f32 v174, v174
  v_max_f32 v34, 0, v34
  v_add_f32 v34, 0x358637bd, v34
  v_add_f32 v34, v34, v174
  v_mul_f32 v35, v14, v35
  v_min_f32 v174, 0, v35
  v_mul_f32 v174, 0x3fb8aa3b, v174
  v_exp_f32 v174, v174
  v_max_f32 v35, 0, v35
  v_add_f32 v35, 0x358637bd, v35
  v_add_f32 v35, v35, v174
  v_cvt_pk_bf16_f32 v182, v32, v33
  v_cvt_pk_bf16_f32 v183, v34, v35
  v_lshlrev_b32 v175, 4, v1
  s_lshl_b32 s6, s3, 2
  s_add_u32 s6, s6, s5
  s_lshl_b32 s6, s6, 14
  s_lshl_b32 s7, s4, 11
  s_add_u32 s6, s6, s7
  s_add_u32 s6, s6, 0
  buffer_store_dwordx4 v[176:179], v175, s[16:19], s6 offen
  buffer_store_dwordx4 v[180:183], v175, s[16:19], s6 offen offset:1024
  s_waitcnt lgkmcnt(0)
  v_mul_f32 v36, v170, v36
  v_min_f32 v174, 0, v36
  v_mul_f32 v174, 0x3fb8aa3b, v174
  v_exp_f32 v174, v174
  v_max_f32 v36, 0, v36
  v_add_f32 v36, 0x358637bd, v36
  v_add_f32 v36, v36, v174
  v_mul_f32 v37, v171, v37
  v_min_f32 v174, 0, v37
  v_mul_f32 v174, 0x3fb8aa3b, v174
  v_exp_f32 v174, v174
  v_max_f32 v37, 0, v37
  v_add_f32 v37, 0x358637bd, v37
  v_add_f32 v37, v37, v174
  v_mul_f32 v38, v172, v38
  v_min_f32 v174, 0, v38
  v_mul_f32 v174, 0x3fb8aa3b, v174
  v_exp_f32 v174, v174
  v_max_f32 v38, 0, v38
  v_add_f32 v38, 0x358637bd, v38
  v_add_f32 v38, v38, v174
  v_mul_f32 v39, v173, v39
  v_min_f32 v174, 0, v39
  v_mul_f32 v174, 0x3fb8aa3b, v174
  v_exp_f32 v174, v174
  v_max_f32 v39, 0, v39
  v_add_f32 v39, 0x358637bd, v39
  v_add_f32 v39, v39, v174
  v_cvt_pk_bf16_f32 v184, v36, v37
  v_cvt_pk_bf16_f32 v185, v38, v39
  v_mul_f32 v40, v170, v40
  v_min_f32 v174, 0, v40
  v_mul_f32 v174, 0x3fb8aa3b, v174
  v_exp_f32 v174, v174
  v_max_f32 v40, 0, v40
  v_add_f32 v40, 0x358637bd, v40
  v_add_f32 v40, v40, v174
  v_mul_f32 v41, v171, v41
  v_min_f32 v174, 0, v41
  v_mul_f32 v174, 0x3fb8aa3b, v174
  v_exp_f32 v174, v174
  v_max_f32 v41, 0, v41
  v_add_f32 v41, 0x358637bd, v41
  v_add_f32 v41, v41, v174
  v_mul_f32 v42, v172, v42
  v_min_f32 v174, 0, v42
  v_mul_f32 v174, 0x3fb8aa3b, v174
  v_exp_f32 v174, v174
  v_max_f32 v42, 0, v42
  v_add_f32 v42, 0x358637bd, v42
  v_add_f32 v42, v42, v174
  v_mul_f32 v43, v173, v43
  v_min_f32 v174, 0, v43
  v_mul_f32 v174, 0x3fb8aa3b, v174
  v_exp_f32 v174, v174
  v_max_f32 v43, 0, v43
  v_add_f32 v43, 0x358637bd, v43
  v_add_f32 v43, v43, v174
  v_cvt_pk_bf16_f32 v186, v40, v41
  v_cvt_pk_bf16_f32 v187, v42, v43
  v_mul_f32 v44, v170, v44
  v_min_f32 v174, 0, v44
  v_mul_f32 v174, 0x3fb8aa3b, v174
  v_exp_f32 v174, v174
  v_max_f32 v44, 0, v44
  v_add_f32 v44, 0x358637bd, v44
  v_add_f32 v44, v44, v174
  v_mul_f32 v45, v171, v45
  v_min_f32 v174, 0, v45
  v_mul_f32 v174, 0x3fb8aa3b, v174
  v_exp_f32 v174, v174
  v_max_f32 v45, 0, v45
  v_add_f32 v45, 0x358637bd, v45
  v_add_f32 v45, v45, v174
  v_mul_f32 v46, v172, v46
  v_min_f32 v174, 0, v46
  v_mul_f32 v174, 0x3fb8aa3b, v174
  v_exp_f32 v174, v174
  v_max_f32 v46, 0, v46
  v_add_f32 v46, 0x358637bd, v46
  v_add_f32 v46, v46, v174
  v_mul_f32 v47, v173, v47
  v_min_f32 v174, 0, v47
  v_mul_f32 v174, 0x3fb8aa3b, v174
  v_exp_f32 v174, v174
  v_max_f32 v47, 0, v47
  v_add_f32 v47, 0x358637bd, v47
  v_add_f32 v47, v47, v174
  v_cvt_pk_bf16_f32 v188, v44, v45
  v_cvt_pk_bf16_f32 v189, v46, v47
  v_mul_f32 v48, v170, v48
  v_min_f32 v174, 0, v48
  v_mul_f32 v174, 0x3fb8aa3b, v174
  v_exp_f32 v174, v174
  v_max_f32 v48, 0, v48
  v_add_f32 v48, 0x358637bd, v48
  v_add_f32 v48, v48, v174
  v_mul_f32 v49, v171, v49
  v_min_f32 v174, 0, v49
  v_mul_f32 v174, 0x3fb8aa3b, v174
  v_exp_f32 v174, v174
  v_max_f32 v49, 0, v49
  v_add_f32 v49, 0x358637bd, v49
  v_add_f32 v49, v49, v174
  v_mul_f32 v50, v172, v50
  v_min_f32 v174, 0, v50
  v_mul_f32 v174, 0x3fb8aa3b, v174
  v_exp_f32 v174, v174
  v_max_f32 v50, 0, v50
  v_add_f32 v50, 0x358637bd, v50
  v_add_f32 v50, v50, v174
  v_mul_f32 v51, v173, v51
  v_min_f32 v174, 0, v51
  v_mul_f32 v174, 0x3fb8aa3b, v174
  v_exp_f32 v174, v174
  v_max_f32 v51, 0, v51
  v_add_f32 v51, 0x358637bd, v51
  v_add_f32 v51, v51, v174
  v_cvt_pk_bf16_f32 v190, v48, v49
  v_cvt_pk_bf16_f32 v191, v50, v51
  v_mul_f32 v52, v170, v52
  v_mul_f32 v53, v171, v53
  v_mul_f32 v54, v172, v54
  v_mul_f32 v55, v173, v55
  v_cvt_pk_bf16_f32 v192, v52, v53
  v_cvt_pk_bf16_f32 v193, v54, v55
  v_mul_f32 v56, v170, v56
  v_mul_f32 v57, v171, v57
  v_mul_f32 v58, v172, v58
  v_mul_f32 v59, v173, v59
  v_cvt_pk_bf16_f32 v194, v56, v57
  v_cvt_pk_bf16_f32 v195, v58, v59
  v_mul_f32 v60, v170, v60
  v_mul_f32 v61, v171, v61
  v_mul_f32 v62, v172, v62
  v_mul_f32 v63, v173, v63
  v_cvt_pk_bf16_f32 v196, v60, v61
  v_cvt_pk_bf16_f32 v197, v62, v63
  v_mul_f32 v64, v170, v64
  v_mul_f32 v65, v171, v65
  v_mul_f32 v66, v172, v66
  v_mul_f32 v67, v173, v67
  v_cvt_pk_bf16_f32 v198, v64, v65
  v_cvt_pk_bf16_f32 v199, v66, v67
  v_mov_b32 v200, s30
  v_mov_b32 v201, s30
  s_nop 1
  v_mfma_f32_16x16x16_bf16 v[204:207], v[184:185], v[192:193], 0
  v_mfma_f32_16x16x16_bf16 v[220:223], v[184:185], v[200:201], 0
  v_mfma_f32_16x16x16_bf16 v[208:211], v[186:187], v[194:195], 0
  v_mfma_f32_16x16x16_bf16 v[224:227], v[186:187], v[200:201], 0
  v_mfma_f32_16x16x16_bf16 v[212:215], v[188:189], v[196:197], 0
  v_mfma_f32_16x16x16_bf16 v[228:231], v[188:189], v[200:201], 0
  v_mfma_f32_16x16x16_bf16 v[216:219], v[190:191], v[198:199], 0
  v_mfma_f32_16x16x16_bf16 v[232:235], v[190:191], v[200:201], 0
  s_barrier
  s_mul_i32 s6, s5, 4352
  v_lshlrev_b32 v174, 6, v3
  v_lshl_add_u32 v174, v2, 4, v174
  v_add_u32 v174, s6, v174
  v_lshlrev_b32 v175, 4, v2
  v_add_u32 v175, s6, v175
  s_nop 4
  ds_write_b128 v174, v[204:207] offset:0
  ds_write_b128 v175, v[220:223] offset:4096
  ds_write_b128 v174, v[208:211] offset:1024
  ds_write_b128 v175, v[224:227] offset:4160
  ds_write_b128 v174, v[212:215] offset:2048
  ds_write_b128 v175, v[228:231] offset:4224
  ds_write_b128 v174, v[216:219] offset:3072
  ds_write_b128 v175, v[232:235] offset:4288
  s_waitcnt lgkmcnt(0)
  s_barrier
  v_lshlrev_b32 v174, 2, v0
  ds_read_b32 v176, v174 offset:0
  ds_read_b32 v177, v174 offset:4352
  ds_read_b32 v178, v174 offset:8704
  ds_read_b32 v179, v174 offset:13056
  ds_read_b32 v180, v174 offset:1024
  ds_read_b32 v181, v174 offset:5376
  ds_read_b32 v182, v174 offset:9728
  ds_read_b32 v183, v174 offset:14080
  ds_read_b32 v184, v174 offset:2048
  ds_read_b32 v185, v174 offset:6400
  ds_read_b32 v186, v174 offset:10752
  ds_read_b32 v187, v174 offset:15104
  ds_read_b32 v188, v174 offset:3072
  ds_read_b32 v189, v174 offset:7424
  ds_read_b32 v190, v174 offset:11776
  ds_read_b32 v191, v174 offset:16128
  ds_read_b32 v192, v174 offset:4096
  ds_read_b32 v193, v174 offset:8448
  ds_read_b32 v194, v174 offset:12800
  ds_read_b32 v195, v174 offset:17152
  s_waitcnt lgkmcnt(0)
  v_add_f32 v176, v176, v177
  v_add_f32 v176, v176, v178
  v_add_f32 v176, v176, v179
  v_add_f32 v180, v180, v181
  v_add_f32 v180, v180, v182
  v_add_f32 v180, v180, v183
  v_add_f32 v184, v184, v185
  v_add_f32 v184, v184, v186
  v_add_f32 v184, v184, v187
  v_add_f32 v188, v188, v189
  v_add_f32 v188, v188, v190
  v_add_f32 v188, v188, v191
  v_add_f32 v192, v192, v193
  v_add_f32 v192, v192, v194
  v_add_f32 v192, v192, v195
  s_cmp_eq_u32 s3, 0
  s_cbranch_scc1 k1_kernel_go
  s_waitcnt vmcnt(0)
  v_readfirstlane_b32 s6, v164
  s_cmp_lg_u32 s6, 0
  s_cbranch_scc1 k1_kernel_go
k1_kernel_poll:
  s_sleep 1
  buffer_load_dword v164, v165, s[20:23], 0 offen sc0 sc1
  s_waitcnt vmcnt(0)
  v_readfirstlane_b32 s6, v164
  s_cmp_eq_u32 s6, 0
  s_cbranch_scc1 k1_kernel_poll
k1_kernel_go:
  buffer_atomic_add_f32 v176, v174, s[24:27], 0 offen offset:0
  buffer_atomic_add_f32 v180, v174, s[24:27], 0 offen offset:1024
  buffer_atomic_add_f32 v184, v174, s[24:27], 0 offen offset:2048
  buffer_atomic_add_f32 v188, v174, s[24:27], 0 offen offset:3072
  s_movk_i32 s6, 4096
  buffer_atomic_add_f32 v192, v174, s[24:27], s6 offen
k1_kernel_end:
  s_endpgm
.globl k2_kernel
.p2align 8
.type k2_kernel,@function
k2_kernel:
  s_cmp_ge_u32 s2, 256
  s_cbranch_scc1 k2_kernel_end
  s_load_dwordx2 s[36:37], s[0:1], 0
  s_load_dwordx2 s[38:39], s[0:1], 16
  s_load_dwordx2 s[42:43], s[0:1], 64
  s_and_b32 s6, s2, 7
  s_lshr_b32 s7, s6, 1
  s_lshl_b32 s3, s7, 3
  s_bfe_u32 s7, s2, 0x30003
  s_add_u32 s3, s3, s7
  s_and_b32 s7, s6, 1
  s_lshl_b32 s4, s7, 2
  s_lshr_b32 s7, s2, 6
  s_add_u32 s4, s4, s7
  v_and_b32 v1, 63, v0
  v_lshrrev_b32 v4, 6, v0
  v_lshrrev_b32 v2, 4, v1
  v_readfirstlane_b32 s5, v4
  v_and_b32 v3, 15, v1
  s_waitcnt lgkmcnt(0)
  s_lshl_b32 s6, s4, 7
  s_add_u32 s8, s38, s6
  s_addc_u32 s9, s39, 0
  s_sub_u32 s10, 524288, s6
  s_mov_b32 s11, 0x00020000
  s_mov_b32 s12, s42
  s_mov_b32 s13, s43
  s_mov_b32 s14, 268435456
  s_mov_b32 s15, 0x00020000
  s_lshl_b32 s7, s3, 16
  s_add_u32 s6, s6, s7
  s_add_u32 s16, s36, s6
  s_addc_u32 s17, s37, 0
  s_sub_u32 s18, 2097152, s6
  s_mov_b32 s19, 0x00020000
  v_lshlrev_b32 v12, 6, v3
  v_lshl_add_u32 v12, v2, 4, v12
  v_lshlrev_b32 v4, 4, v2
  s_mul_i32 s6, s5, 8704
  s_add_u32 s6, s6, 2097152
  s_add_u32 s7, s6, 0
  buffer_load_dwordx4 v[24:27], v12, s[12:15], s7 offen
  s_add_u32 s7, s6, 1024
  buffer_load_dwordx4 v[28:31], v12, s[12:15], s7 offen
  s_add_u32 s7, s6, 4096
  buffer_load_dwordx4 v[32:35], v4, s[12:15], s7 offen
  s_add_u32 s7, s6, 4160
  buffer_load_dwordx4 v[36:39], v4, s[12:15], s7 offen
  s_add_u32 s7, s6, 2048
  buffer_load_dwordx4 v[40:43], v12, s[12:15], s7 offen
  s_add_u32 s7, s6, 3072
  buffer_load_dwordx4 v[44:47], v12, s[12:15], s7 offen
  s_add_u32 s7, s6, 4224
  buffer_load_dwordx4 v[48:51], v4, s[12:15], s7 offen
  s_add_u32 s7, s6, 4288
  buffer_load_dwordx4 v[52:55], v4, s[12:15], s7 offen
  s_add_u32 s7, s6, 4352
  buffer_load_dwordx4 v[56:59], v12, s[12:15], s7 offen
  s_add_u32 s7, s6, 5376
  buffer_load_dwordx4 v[60:63], v12, s[12:15], s7 offen
  s_add_u32 s7, s6, 8448
  buffer_load_dwordx4 v[64:67], v4, s[12:15], s7 offen
  s_add_u32 s7, s6, 8512
  buffer_load_dwordx4 v[68:71], v4, s[12:15], s7 offen
  s_add_u32 s7, s6, 6400
  buffer_load_dwordx4 v[72:75], v12, s[12:15], s7 offen
  s_add_u32 s7, s6, 7424
  buffer_load_dwordx4 v[76:79], v12, s[12:15], s7 offen
  s_add_u32 s7, s6, 8576
  buffer_load_dwordx4 v[80:83], v4, s[12:15], s7 offen
  s_add_u32 s7, s6, 8640
  buffer_load_dwordx4 v[84:87], v4, s[12:15], s7 offen
  v_lshlrev_b32 v13, 4, v1
  s_lshl_b32 s6, s3, 16
  s_lshl_b32 s7, s5, 12
  s_add_u32 s6, s6, s7
  s_add_u32 s6, s6, 0
  s_add_u32 s7, s6, 0
  buffer_load_dwordx4 v[88:91], v13, s[12:15], s7 offen
  s_add_u32 s7, s6, 16384
  buffer_load_dwordx4 v[92:95], v13, s[12:15], s7 offen
  s_add_u32 s7, s6, 32768
  buffer_load_dwordx4 v[96:99], v13, s[12:15], s7 offen
  s_add_u32 s7, s6, 49152
  buffer_load_dwordx4 v[100:103], v13, s[12:15], s7 offen
  s_add_u32 s7, s6, 1024
  buffer_load_dwordx4 v[104:107], v13, s[12:15], s7 offen
  s_add_u32 s7, s6, 17408
  buffer_load_dwordx4 v[108:111], v13, s[12:15], s7 offen
  s_add_u32 s7, s6, 33792
  buffer_load_dwordx4 v[112:115], v13, s[12:15], s7 offen
  s_add_u32 s7, s6, 50176
  buffer_load_dwordx4 v[116:119], v13, s[12:15], s7 offen
  s_add_u32 s7, s6, 2048
  buffer_load_dwordx4 v[120:123], v13, s[12:15], s7 offen
  s_add_u32 s7, s6, 18432
  buffer_load_dwordx4 v[124:127], v13, s[12:15], s7 offen
  s_add_u32 s7, s6, 34816
  buffer_load_dwordx4 v[128:131], v13, s[12:15], s7 offen
  s_add_u32 s7, s6, 51200
  buffer_load_dwordx4 v[132:135], v13, s[12:15], s7 offen
  s_add_u32 s7, s6, 3072
  buffer_load_dwordx4 v[136:139], v13, s[12:15], s7 offen
  s_add_u32 s7, s6, 19456
  buffer_load_dwordx4 v[140:143], v13, s[12:15], s7 offen
  s_add_u32 s7, s6, 35840
  buffer_load_dwordx4 v[144:147], v13, s[12:15], s7 offen
  s_add_u32 s7, s6, 52224
  buffer_load_dwordx4 v[148:151], v13, s[12:15], s7 offen
  v_lshrrev_b32 v4, 3, v1
  v_lshlrev_b32 v14, 10, v4
  v_bfe_u32 v4, v1, 1, 2
  v_bfe_u32 v5, v1, 4, 2
  v_xor_b32 v4, v4, v5
  v_and_b32 v5, 1, v1
  v_lshl_or_b32 v4, v4, 1, v5
  v_lshl_add_u32 v14, v4, 4, v14
  s_lshl_b32 s6, s5, 13
  s_lshl_b32 s7, s5, 10
  s_add_u32 m0, s7, 0
  s_add_u32 s44, s6, 0
  buffer_load_dwordx4 v14, s[8:11], s44 offen lds
  s_add_u32 m0, s7, 4096
  s_add_u32 s44, s6, 32768
  buffer_load_dwordx4 v14, s[8:11], s44 offen lds
  s_add_u32 m0, s7, 8192
  s_add_u32 s44, s6, 65536
  buffer_load_dwordx4 v14, s[8:11], s44 offen lds
  s_add_u32 m0, s7, 12288
  s_add_u32 s44, s6, 98304
  buffer_load_dwordx4 v14, s[8:11], s44 offen lds
  s_add_u32 m0, s7, 16384
  s_add_u32 s44, s6, 131072
  buffer_load_dwordx4 v14, s[8:11], s44 offen lds
  s_add_u32 m0, s7, 20480
  s_add_u32 s44, s6, 163840
  buffer_load_dwordx4 v14, s[8:11], s44 offen lds
  s_add_u32 m0, s7, 24576
  s_add_u32 s44, s6, 196608
  buffer_load_dwordx4 v14, s[8:11], s44 offen lds
  s_add_u32 m0, s7, 28672
  s_add_u32 s44, s6, 229376
  buffer_load_dwordx4 v14, s[8:11], s44 offen lds
  s_add_u32 m0, s7, 32768
  s_add_u32 s44, s6, 262144
  buffer_load_dwordx4 v14, s[8:11], s44 offen lds
  s_add_u32 m0, s7, 36864
  s_add_u32 s44, s6, 294912
  buffer_load_dwordx4 v14, s[8:11], s44 offen lds
  s_add_u32 m0, s7, 40960
  s_add_u32 s44, s6, 327680
  buffer_load_dwordx4 v14, s[8:11], s44 offen lds
  s_add_u32 m0, s7, 45056
  s_add_u32 s44, s6, 360448
  buffer_load_dwordx4 v14, s[8:11], s44 offen lds
  s_add_u32 m0, s7, 49152
  s_add_u32 s44, s6, 393216
  buffer_load_dwordx4 v14, s[8:11], s44 offen lds
  s_add_u32 m0, s7, 53248
  s_add_u32 s44, s6, 425984
  buffer_load_dwordx4 v14, s[8:11], s44 offen lds
  s_add_u32 m0, s7, 57344
  s_add_u32 s44, s6, 458752
  buffer_load_dwordx4 v14, s[8:11], s44 offen lds
  s_add_u32 m0, s7, 61440
  s_add_u32 s44, s6, 491520
  buffer_load_dwordx4 v14, s[8:11], s44 offen lds
  s_lshr_b32 s6, s5, 1
  s_lshl_b32 s6, s6, 15
  s_and_b32 s7, s5, 1
  s_lshl_b32 s7, s7, 6
  s_add_u32 s6, s6, s7
  v_lshlrev_b32 v15, 10, v3
  v_lshl_add_u32 v15, v2, 3, v15
  s_add_u32 s7, s6, 16384
  buffer_load_dwordx2 v[152:153], v15, s[16:19], s6 offen offset:0
  buffer_load_dwordx2 v[154:155], v15, s[16:19], s6 offen offset:32
  buffer_load_dwordx2 v[156:157], v15, s[16:19], s7 offen offset:0
  buffer_load_dwordx2 v[158:159], v15, s[16:19], s7 offen offset:32
  v_bfe_u32 v4, v1, 2, 2
  v_lshl_add_u32 v5, v2, 2, v4
  v_lshlrev_b32 v5, 7, v5
  v_and_b32 v6, 3, v1
  v_lshl_add_u32 v5, v6, 3, v5
  v_lshrrev_b32 v4, 1, v4
  v_lshl_add_u32 v4, v2, 1, v4
  v_and_b32 v4, 3, v4
  v_xor_b32 v6, 0, v4
  v_lshl_add_u32 v16, v6, 5, v5
  v_xor_b32 v6, 1, v4
  v_lshl_add_u32 v17, v6, 5, v5
  v_xor_b32 v6, 2, v4
  v_lshl_add_u32 v18, v6, 5, v5
  v_xor_b32 v6, 3, v4
  v_lshl_add_u32 v19, v6, 5, v5
  v_lshlrev_b32 v20, 4, v1
  s_waitcnt vmcnt(36)
  v_cvt_pk_bf16_f32 v24, v24, v25
  v_cvt_pk_bf16_f32 v25, v26, v27
  v_cvt_pk_bf16_f32 v28, v28, v29
  v_cvt_pk_bf16_f32 v29, v30, v31
  v_cvt_pk_bf16_f32 v32, v32, v33
  v_cvt_pk_bf16_f32 v33, v34, v35
  v_cvt_pk_bf16_f32 v36, v36, v37
  v_cvt_pk_bf16_f32 v37, v38, v39
  v_cvt_pk_bf16_f32 v40, v40, v41
  v_cvt_pk_bf16_f32 v41, v42, v43
  v_cvt_pk_bf16_f32 v44, v44, v45
  v_cvt_pk_bf16_f32 v45, v46, v47
  v_cvt_pk_bf16_f32 v48, v48, v49
  v_cvt_pk_bf16_f32 v49, v50, v51
  v_cvt_pk_bf16_f32 v52, v52, v53
  v_cvt_pk_bf16_f32 v53, v54, v55
  v_cvt_pk_bf16_f32 v56, v56, v57
  v_cvt_pk_bf16_f32 v57, v58, v59
  v_cvt_pk_bf16_f32 v60, v60, v61
  v_cvt_pk_bf16_f32 v61, v62, v63
  v_cvt_pk_bf16_f32 v64, v64, v65
  v_cvt_pk_bf16_f32 v65, v66, v67
  v_cvt_pk_bf16_f32 v68, v68, v69
  v_cvt_pk_bf16_f32 v69, v70, v71
  v_cvt_pk_bf16_f32 v72, v72, v73
  v_cvt_pk_bf16_f32 v73, v74, v75
  v_cvt_pk_bf16_f32 v76, v76, v77
  v_cvt_pk_bf16_f32 v77, v78, v79
  v_cvt_pk_bf16_f32 v80, v80, v81
  v_cvt_pk_bf16_f32 v81, v82, v83
  v_cvt_pk_bf16_f32 v84, v84, v85
  v_cvt_pk_bf16_f32 v85, v86, v87
  s_waitcnt vmcnt(20)
  s_lshl_b32 s6, s5, 12
  s_add_u32 s6, s6, 65536
  v_add_u32 v21, s6, v20
  s_nop 1
  v_mfma_f32_16x16x16_bf16 v[208:211], v[24:25], v[88:89], 0
  v_mfma_f32_16x16x16_bf16 v[212:215], v[32:33], v[88:89], 0
  v_mfma_f32_16x16x16_bf16 v[216:219], v[28:29], v[90:91], 0
  v_mfma_f32_16x16x16_bf16 v[220:223], v[36:37], v[90:91], 0
  v_mfma_f32_16x16x16_bf16 v[224:227], v[24:25], v[92:93], 0
  v_mfma_f32_16x16x16_bf16 v[228:231], v[32:33], v[92:93], 0
  v_mfma_f32_16x16x16_bf16 v[232:235], v[28:29], v[94:95], 0
  v_mfma_f32_16x16x16_bf16 v[236:239], v[36:37], v[94:95], 0
  s_nop 3
  v_add_f32 v212, 0x358637bd, v212
  v_rcp_f32 v212, v212
  s_nop 0
  v_mul_f32 v208, v208, v212
  v_mul_f32 v209, v209, v212
  v_mul_f32 v210, v210, v212
  v_mul_f32 v211, v211, v212
  v_add_f32 v220, 0x358637bd, v220
  v_rcp_f32 v220, v220
  s_nop 0
  v_mul_f32 v216, v216, v220
  v_mul_f32 v217, v217, v220
  v_mul_f32 v218, v218, v220
  v_mul_f32 v219, v219, v220
  v_cvt_pk_bf16_f32 v212, v208, v209
  v_cvt_pk_bf16_f32 v213, v210, v211
  v_cvt_pk_bf16_f32 v214, v216, v217
  v_cvt_pk_bf16_f32 v215, v218, v219
  ds_write_b128 v21, v[212:215] offset:0
  v_mfma_f32_16x16x16_bf16 v[208:211], v[24:25], v[96:97], 0
  v_mfma_f32_16x16x16_bf16 v[212:215], v[32:33], v[96:97], 0
  v_mfma_f32_16x16x16_bf16 v[216:219], v[28:29], v[98:99], 0
  v_mfma_f32_16x16x16_bf16 v[220:223], v[36:37], v[98:99], 0
  s_nop 3
  v_add_f32 v228, 0x358637bd, v228
  v_rcp_f32 v228, v228
  s_nop 0
  v_mul_f32 v224, v224, v228
  v_mul_f32 v225, v225, v228
  v_mul_f32 v226, v226, v228
  v_mul_f32 v227, v227, v228
  v_add_f32 v236, 0x358637bd, v236
  v_rcp_f32 v236, v236
  s_nop 0
  v_mul_f32 v232, v232, v236
  v_mul_f32 v233, v233, v236
  v_mul_f32 v234, v234, v236
  v_mul_f32 v235, v235, v236
  v_cvt_pk_bf16_f32 v228, v224, v225
  v_cvt_pk_bf16_f32 v229, v226, v227
  v_cvt_pk_bf16_f32 v230, v232, v233
  v_cvt_pk_bf16_f32 v231, v234, v235
  ds_write_b128 v21, v[228:231] offset:16384
  v_mfma_f32_16x16x16_bf16 v[224:227], v[24:25], v[100:101], 0
  v_mfma_f32_16x16x16_bf16 v[228:231], v[32:33], v[100:101], 0
  v_mfma_f32_16x16x16_bf16 v[232:235], v[28:29], v[102:103], 0
  v_mfma_f32_16x16x16_bf16 v[236:239], v[36:37], v[102:103], 0
  s_nop 3
  v_add_f32 v212, 0x358637bd, v212
  v_rcp_f32 v212, v212
  s_nop 0
  v_mul_f32 v208, v208, v212
  v_mul_f32 v209, v209, v212
  v_mul_f32 v210, v210, v212
  v_mul_f32 v211, v211, v212
  v_add_f32 v220, 0x358637bd, v220
  v_rcp_f32 v220, v220
  s_nop 0
  v_mul_f32 v216, v216, v220
  v_mul_f32 v217, v217, v220
  v_mul_f32 v218, v218, v220
  v_mul_f32 v219, v219, v220
  v_cvt_pk_bf16_f32 v212, v208, v209
  v_cvt_pk_bf16_f32 v213, v210, v211
  v_cvt_pk_bf16_f32 v214, v216, v217
  v_cvt_pk_bf16_f32 v215, v218, v219
  ds_write_b128 v21, v[212:215] offset:32768
  v_mfma_f32_16x16x16_bf16 v[208:211], v[40:41], v[104:105], 0
  v_mfma_f32_16x16x16_bf16 v[212:215], v[48:49], v[104:105], 0
  v_mfma_f32_16x16x16_bf16 v[216:219], v[44:45], v[106:107], 0
  v_mfma_f32_16x16x16_bf16 v[220:223], v[52:53], v[106:107], 0
  s_nop 3
  v_add_f32 v228, 0x358637bd, v228
  v_rcp_f32 v228, v228
  s_nop 0
  v_mul_f32 v224, v224, v228
  v_mul_f32 v225, v225, v228
  v_mul_f32 v226, v226, v228
  v_mul_f32 v227, v227, v228
  v_add_f32 v236, 0x358637bd, v236
  v_rcp_f32 v236, v236
  s_nop 0
  v_mul_f32 v232, v232, v236
  v_mul_f32 v233, v233, v236
  v_mul_f32 v234, v234, v236
  v_mul_f32 v235, v235, v236
  v_cvt_pk_bf16_f32 v228, v224, v225
  v_cvt_pk_bf16_f32 v229, v226, v227
  v_cvt_pk_bf16_f32 v230, v232, v233
  v_cvt_pk_bf16_f32 v231, v234, v235
  ds_write_b128 v21, v[228:231] offset:49152
  v_mfma_f32_16x16x16_bf16 v[224:227], v[40:41], v[108:109], 0
  v_mfma_f32_16x16x16_bf16 v[228:231], v[48:49], v[108:109], 0
  v_mfma_f32_16x16x16_bf16 v[232:235], v[44:45], v[110:111], 0
  v_mfma_f32_16x16x16_bf16 v[236:239], v[52:53], v[110:111], 0
  s_nop 3
  v_add_f32 v212, 0x358637bd, v212
  v_rcp_f32 v212, v212
  s_nop 0
  v_mul_f32 v208, v208, v212
  v_mul_f32 v209, v209, v212
  v_mul_f32 v210, v210, v212
  v_mul_f32 v211, v211, v212
  v_add_f32 v220, 0x358637bd, v220
  v_rcp_f32 v220, v220
  s_nop 0
  v_mul_f32 v216, v216, v220
  v_mul_f32 v217, v217, v220
  v_mul_f32 v218, v218, v220
  v_mul_f32 v219, v219, v220
  v_cvt_pk_bf16_f32 v212, v208, v209
  v_cvt_pk_bf16_f32 v213, v210, v211
  v_cvt_pk_bf16_f32 v214, v216, v217
  v_cvt_pk_bf16_f32 v215, v218, v219
  ds_write_b128 v21, v[212:215] offset:1024
  v_mfma_f32_16x16x16_bf16 v[208:211], v[40:41], v[112:113], 0
  v_mfma_f32_16x16x16_bf16 v[212:215], v[48:49], v[112:113], 0
  v_mfma_f32_16x16x16_bf16 v[216:219], v[44:45], v[114:115], 0
  v_mfma_f32_16x16x16_bf16 v[220:223], v[52:53], v[114:115], 0
  s_nop 3
  v_add_f32 v228, 0x358637bd, v228
  v_rcp_f32 v228, v228
  s_nop 0
  v_mul_f32 v224, v224, v228
  v_mul_f32 v225, v225, v228
  v_mul_f32 v226, v226, v228
  v_mul_f32 v227, v227, v228
  v_add_f32 v236, 0x358637bd, v236
  v_rcp_f32 v236, v236
  s_nop 0
  v_mul_f32 v232, v232, v236
  v_mul_f32 v233, v233, v236
  v_mul_f32 v234, v234, v236
  v_mul_f32 v235, v235, v236
  v_cvt_pk_bf16_f32 v228, v224, v225
  v_cvt_pk_bf16_f32 v229, v226, v227
  v_cvt_pk_bf16_f32 v230, v232, v233
  v_cvt_pk_bf16_f32 v231, v234, v235
  ds_write_b128 v21, v[228:231] offset:17408
  v_mfma_f32_16x16x16_bf16 v[224:227], v[40:41], v[116:117], 0
  v_mfma_f32_16x16x16_bf16 v[228:231], v[48:49], v[116:117], 0
  v_mfma_f32_16x16x16_bf16 v[232:235], v[44:45], v[118:119], 0
  v_mfma_f32_16x16x16_bf16 v[236:239], v[52:53], v[118:119], 0
  s_nop 3
  v_add_f32 v212, 0x358637bd, v212
  v_rcp_f32 v212, v212
  s_nop 0
  v_mul_f32 v208, v208, v212
  v_mul_f32 v209, v209, v212
  v_mul_f32 v210, v210, v212
  v_mul_f32 v211, v211, v212
  v_add_f32 v220, 0x358637bd, v220
  v_rcp_f32 v220, v220
  s_nop 0
  v_mul_f32 v216, v216, v220
  v_mul_f32 v217, v217, v220
  v_mul_f32 v218, v218, v220
  v_mul_f32 v219, v219, v220
  v_cvt_pk_bf16_f32 v212, v208, v209
  v_cvt_pk_bf16_f32 v213, v210, v211
  v_cvt_pk_bf16_f32 v214, v216, v217
  v_cvt_pk_bf16_f32 v215, v218, v219
  ds_write_b128 v21, v[212:215] offset:33792
  v_mfma_f32_16x16x16_bf16 v[208:211], v[56:57], v[120:121], 0
  v_mfma_f32_16x16x16_bf16 v[212:215], v[64:65], v[120:121], 0
  v_mfma_f32_16x16x16_bf16 v[216:219], v[60:61], v[122:123], 0
  v_mfma_f32_16x16x16_bf16 v[220:223], v[68:69], v[122:123], 0
  s_nop 3
  v_add_f32 v228, 0x358637bd, v228
  v_rcp_f32 v228, v228
  s_nop 0
  v_mul_f32 v224, v224, v228
  v_mul_f32 v225, v225, v228
  v_mul_f32 v226, v226, v228
  v_mul_f32 v227, v227, v228
  v_add_f32 v236, 0x358637bd, v236
  v_rcp_f32 v236, v236
  s_nop 0
  v_mul_f32 v232, v232, v236
  v_mul_f32 v233, v233, v236
  v_mul_f32 v234, v234, v236
  v_mul_f32 v235, v235, v236
  v_cvt_pk_bf16_f32 v228, v224, v225
  v_cvt_pk_bf16_f32 v229, v226, v227
  v_cvt_pk_bf16_f32 v230, v232, v233
  v_cvt_pk_bf16_f32 v231, v234, v235
  ds_write_b128 v21, v[228:231] offset:50176
  v_mfma_f32_16x16x16_bf16 v[224:227], v[56:57], v[124:125], 0
  v_mfma_f32_16x16x16_bf16 v[228:231], v[64:65], v[124:125], 0
  v_mfma_f32_16x16x16_bf16 v[232:235], v[60:61], v[126:127], 0
  v_mfma_f32_16x16x16_bf16 v[236:239], v[68:69], v[126:127], 0
  s_nop 3
  v_add_f32 v212, 0x358637bd, v212
  v_rcp_f32 v212, v212
  s_nop 0
  v_mul_f32 v208, v208, v212
  v_mul_f32 v209, v209, v212
  v_mul_f32 v210, v210, v212
  v_mul_f32 v211, v211, v212
  v_add_f32 v220, 0x358637bd, v220
  v_rcp_f32 v220, v220
  s_nop 0
  v_mul_f32 v216, v216, v220
  v_mul_f32 v217, v217, v220
  v_mul_f32 v218, v218, v220
  v_mul_f32 v219, v219, v220
  v_cvt_pk_bf16_f32 v212, v208, v209
  v_cvt_pk_bf16_f32 v213, v210, v211
  v_cvt_pk_bf16_f32 v214, v216, v217
  v_cvt_pk_bf16_f32 v215, v218, v219
  ds_write_b128 v21, v[212:215] offset:2048
  v_mfma_f32_16x16x16_bf16 v[208:211], v[56:57], v[128:129], 0
  v_mfma_f32_16x16x16_bf16 v[212:215], v[64:65], v[128:129], 0
  v_mfma_f32_16x16x16_bf16 v[216:219], v[60:61], v[130:131], 0
  v_mfma_f32_16x16x16_bf16 v[220:223], v[68:69], v[130:131], 0
  s_nop 3
  v_add_f32 v228, 0x358637bd, v228
  v_rcp_f32 v228, v228
  s_nop 0
  v_mul_f32 v224, v224, v228
  v_mul_f32 v225, v225, v228
  v_mul_f32 v226, v226, v228
  v_mul_f32 v227, v227, v228
  v_add_f32 v236, 0x358637bd, v236
  v_rcp_f32 v236, v236
  s_nop 0
  v_mul_f32 v232, v232, v236
  v_mul_f32 v233, v233, v236
  v_mul_f32 v234, v234, v236
  v_mul_f32 v235, v235, v236
  v_cvt_pk_bf16_f32 v228, v224, v225
  v_cvt_pk_bf16_f32 v229, v226, v227
  v_cvt_pk_bf16_f32 v230, v232, v233
  v_cvt_pk_bf16_f32 v231, v234, v235
  ds_write_b128 v21, v[228:231] offset:18432
  v_mfma_f32_16x16x16_bf16 v[224:227], v[56:57], v[132:133], 0
  v_mfma_f32_16x16x16_bf16 v[228:231], v[64:65], v[132:133], 0
  v_mfma_f32_16x16x16_bf16 v[232:235], v[60:61], v[134:135], 0
  v_mfma_f32_16x16x16_bf16 v[236:239], v[68:69], v[134:135], 0
  s_nop 3
  v_add_f32 v212, 0x358637bd, v212
  v_rcp_f32 v212, v212
  s_nop 0
  v_mul_f32 v208, v208, v212
  v_mul_f32 v209, v209, v212
  v_mul_f32 v210, v210, v212
  v_mul_f32 v211, v211, v212
  v_add_f32 v220, 0x358637bd, v220
  v_rcp_f32 v220, v220
  s_nop 0
  v_mul_f32 v216, v216, v220
  v_mul_f32 v217, v217, v220
  v_mul_f32 v218, v218, v220
  v_mul_f32 v219, v219, v220
  v_cvt_pk_bf16_f32 v212, v208, v209
  v_cvt_pk_bf16_f32 v213, v210, v211
  v_cvt_pk_bf16_f32 v214, v216, v217
  v_cvt_pk_bf16_f32 v215, v218, v219
  ds_write_b128 v21, v[212:215] offset:34816
  v_mfma_f32_16x16x16_bf16 v[208:211], v[72:73], v[136:137], 0
  v_mfma_f32_16x16x16_bf16 v[212:215], v[80:81], v[136:137], 0
  v_mfma_f32_16x16x16_bf16 v[216:219], v[76:77], v[138:139], 0
  v_mfma_f32_16x16x16_bf16 v[220:223], v[84:85], v[138:139], 0
  s_nop 3
  v_add_f32 v228, 0x358637bd, v228
  v_rcp_f32 v228, v228
  s_nop 0
  v_mul_f32 v224, v224, v228
  v_mul_f32 v225, v225, v228
  v_mul_f32 v226, v226, v228
  v_mul_f32 v227, v227, v228
  v_add_f32 v236, 0x358637bd, v236
  v_rcp_f32 v236, v236
  s_nop 0
  v_mul_f32 v232, v232, v236
  v_mul_f32 v233, v233, v236
  v_mul_f32 v234, v234, v236
  v_mul_f32 v235, v235, v236
  v_cvt_pk_bf16_f32 v228, v224, v225
  v_cvt_pk_bf16_f32 v229, v226, v227
  v_cvt_pk_bf16_f32 v230, v232, v233
  v_cvt_pk_bf16_f32 v231, v234, v235
  ds_write_b128 v21, v[228:231] offset:51200
  v_mfma_f32_16x16x16_bf16 v[224:227], v[72:73], v[140:141], 0
  v_mfma_f32_16x16x16_bf16 v[228:231], v[80:81], v[140:141], 0
  v_mfma_f32_16x16x16_bf16 v[232:235], v[76:77], v[142:143], 0
  v_mfma_f32_16x16x16_bf16 v[236:239], v[84:85], v[142:143], 0
  s_nop 3
  v_add_f32 v212, 0x358637bd, v212
  v_rcp_f32 v212, v212
  s_nop 0
  v_mul_f32 v208, v208, v212
  v_mul_f32 v209, v209, v212
  v_mul_f32 v210, v210, v212
  v_mul_f32 v211, v211, v212
  v_add_f32 v220, 0x358637bd, v220
  v_rcp_f32 v220, v220
  s_nop 0
  v_mul_f32 v216, v216, v220
  v_mul_f32 v217, v217, v220
  v_mul_f32 v218, v218, v220
  v_mul_f32 v219, v219, v220
  v_cvt_pk_bf16_f32 v212, v208, v209
  v_cvt_pk_bf16_f32 v213, v210, v211
  v_cvt_pk_bf16_f32 v214, v216, v217
  v_cvt_pk_bf16_f32 v215, v218, v219
  ds_write_b128 v21, v[212:215] offset:3072
  v_mfma_f32_16x16x16_bf16 v[208:211], v[72:73], v[144:145], 0
  v_mfma_f32_16x16x16_bf16 v[212:215], v[80:81], v[144:145], 0
  v_mfma_f32_16x16x16_bf16 v[216:219], v[76:77], v[146:147], 0
  v_mfma_f32_16x16x16_bf16 v[220:223], v[84:85], v[146:147], 0
  s_nop 3
  v_add_f32 v228, 0x358637bd, v228
  v_rcp_f32 v228, v228
  s_nop 0
  v_mul_f32 v224, v224, v228
  v_mul_f32 v225, v225, v228
  v_mul_f32 v226, v226, v228
  v_mul_f32 v227, v227, v228
  v_add_f32 v236, 0x358637bd, v236
  v_rcp_f32 v236, v236
  s_nop 0
  v_mul_f32 v232, v232, v236
  v_mul_f32 v233, v233, v236
  v_mul_f32 v234, v234, v236
  v_mul_f32 v235, v235, v236
  v_cvt_pk_bf16_f32 v228, v224, v225
  v_cvt_pk_bf16_f32 v229, v226, v227
  v_cvt_pk_bf16_f32 v230, v232, v233
  v_cvt_pk_bf16_f32 v231, v234, v235
  ds_write_b128 v21, v[228:231] offset:19456
  v_mfma_f32_16x16x16_bf16 v[224:227], v[72:73], v[148:149], 0
  v_mfma_f32_16x16x16_bf16 v[228:231], v[80:81], v[148:149], 0
  v_mfma_f32_16x16x16_bf16 v[232:235], v[76:77], v[150:151], 0
  v_mfma_f32_16x16x16_bf16 v[236:239], v[84:85], v[150:151], 0
  s_nop 3
  v_add_f32 v212, 0x358637bd, v212
  v_rcp_f32 v212, v212
  s_nop 0
  v_mul_f32 v208, v208, v212
  v_mul_f32 v209, v209, v212
  v_mul_f32 v210, v210, v212
  v_mul_f32 v211, v211, v212
  v_add_f32 v220, 0x358637bd, v220
  v_rcp_f32 v220, v220
  s_nop 0
  v_mul_f32 v216, v216, v220
  v_mul_f32 v217, v217, v220
  v_mul_f32 v218, v218, v220
  v_mul_f32 v219, v219, v220
  v_cvt_pk_bf16_f32 v212, v208, v209
  v_cvt_pk_bf16_f32 v213, v210, v211
  v_cvt_pk_bf16_f32 v214, v216, v217
  v_cvt_pk_bf16_f32 v215, v218, v219
  ds_write_b128 v21, v[212:215] offset:35840
  s_nop 7
  s_nop 3
  v_add_f32 v228, 0x358637bd, v228
  v_rcp_f32 v228, v228
  s_nop 0
  v_mul_f32 v224, v224, v228
  v_mul_f32 v225, v225, v228
  v_mul_f32 v226, v226, v228
  v_mul_f32 v227, v227, v228
  v_add_f32 v236, 0x358637bd, v236
  v_rcp_f32 v236, v236
  s_nop 0
  v_mul_f32 v232, v232, v236
  v_mul_f32 v233, v233, v236
  v_mul_f32 v234, v234, v236
  v_mul_f32 v235, v235, v236
  v_cvt_pk_bf16_f32 v228, v224, v225
  v_cvt_pk_bf16_f32 v229, v226, v227
  v_cvt_pk_bf16_f32 v230, v232, v233
  v_cvt_pk_bf16_f32 v231, v234, v235
  ds_write_b128 v21, v[228:231] offset:52224
  s_waitcnt vmcnt(0) lgkmcnt(0)
  s_barrier
  s_cmp_lg_u32 s5, 0
  s_cbranch_scc1 k2_kernel_nopf
  s_load_dwordx2 s[52:53], s[0:1], 40
  s_lshr_b32 s50, s2, 3
  s_and_b32 s51, s2, 1
  s_waitcnt lgkmcnt(0)
  s_mov_b32 s56, s52
  s_mov_b32 s57, s53
  s_mov_b32 s58, 1835008
  s_mov_b32 s59, 0x00020000
  s_mul_i32 s6, s50, 57344
  s_lshl_b32 s7, s51, 9
  s_add_u32 s6, s6, s7
  v_lshrrev_b32 v8, 3, v0
  v_and_b32 v8, 7, v8
  s_mov_b32 s49, 1024
  v_mul_lo_u32 v8, s49, v8
  v_and_b32 v9, 7, v0
  v_lshl_add_u32 v8, v9, 6, v8
  s_add_u32 s49, s6, 0
  buffer_load_dword v9, v8, s[56:59], s49 offen
  s_add_u32 s49, s6, 8192
  buffer_load_dword v9, v8, s[56:59], s49 offen
  s_add_u32 s49, s6, 16384
  buffer_load_dword v9, v8, s[56:59], s49 offen
  s_add_u32 s49, s6, 24576
  buffer_load_dword v9, v8, s[56:59], s49 offen
  s_add_u32 s49, s6, 32768
  buffer_load_dword v9, v8, s[56:59], s49 offen
  s_add_u32 s49, s6, 40960
  buffer_load_dword v9, v8, s[56:59], s49 offen
  s_add_u32 s49, s6, 49152
  buffer_load_dword v9, v8, s[56:59], s49 offen
k2_kernel_nopf:
  s_lshr_b32 s6, s5, 1
  s_lshl_b32 s6, s6, 15
  s_add_u32 s6, s6, 65536
  v_add_u32 v20, s6, v20
  s_and_b32 s6, s5, 1
  s_cmp_eq_u32 s6, 0
  s_cbranch_scc1 k2_kernel_pw0
  v_mov_b32 v16, v18
  v_mov_b32 v17, v19
k2_kernel_pw0:
  ds_read_b64_tr_b16 v[176:177], v16 offset:0
  ds_read_b64_tr_b16 v[178:179], v16 offset:2048
  ds_read_b64_tr_b16 v[180:181], v17 offset:0
  ds_read_b64_tr_b16 v[182:183], v17 offset:2048
  ds_read_b128 v[192:195], v20 offset:0
  ds_read_b128 v[196:199], v20 offset:16384
  ds_read_b64_tr_b16 v[184:185], v16 offset:4096
  ds_read_b64_tr_b16 v[186:187], v16 offset:6144
  ds_read_b64_tr_b16 v[188:189], v17 offset:4096
  ds_read_b64_tr_b16 v[190:191], v17 offset:6144
  ds_read_b128 v[200:203], v20 offset:1024
  ds_read_b128 v[204:207], v20 offset:17408
  s_waitcnt lgkmcnt(6)
  v_mfma_f32_16x16x32_bf16 v[160:163], v[176:179], v[192:195], 0
  v_mfma_f32_16x16x32_bf16 v[164:167], v[180:183], v[192:195], 0
  v_mfma_f32_16x16x32_bf16 v[168:171], v[176:179], v[196:199], 0
  v_mfma_f32_16x16x32_bf16 v[172:175], v[180:183], v[196:199], 0
  ds_read_b64_tr_b16 v[176:177], v16 offset:8192
  ds_read_b64_tr_b16 v[178:179], v16 offset:10240
  ds_read_b64_tr_b16 v[180:181], v17 offset:8192
  ds_read_b64_tr_b16 v[182:183], v17 offset:10240
  ds_read_b128 v[192:195], v20 offset:2048
  ds_read_b128 v[196:199], v20 offset:18432
  s_waitcnt lgkmcnt(6)
  v_mfma_f32_16x16x32_bf16 v[160:163], v[184:187], v[200:203], v[160:163]
  v_mfma_f32_16x16x32_bf16 v[164:167], v[188:191], v[200:203], v[164:167]
  v_mfma_f32_16x16x32_bf16 v[168:171], v[184:187], v[204:207], v[168:171]
  v_mfma_f32_16x16x32_bf16 v[172:175], v[188:191], v[204:207], v[172:175]
  ds_read_b64_tr_b16 v[184:185], v16 offset:12288
  ds_read_b64_tr_b16 v[186:187], v16 offset:14336
  ds_read_b64_tr_b16 v[188:189], v17 offset:12288
  ds_read_b64_tr_b16 v[190:191], v17 offset:14336
  ds_read_b128 v[200:203], v20 offset:3072
  ds_read_b128 v[204:207], v20 offset:19456
  s_waitcnt lgkmcnt(6)
  v_mfma_f32_16x16x32_bf16 v[160:163], v[176:179], v[192:195], v[160:163]
  v_mfma_f32_16x16x32_bf16 v[164:167], v[180:183], v[192:195], v[164:167]
  v_mfma_f32_16x16x32_bf16 v[168:171], v[176:179], v[196:199], v[168:171]
  v_mfma_f32_16x16x32_bf16 v[172:175], v[180:183], v[196:199], v[172:175]
  ds_read_b64_tr_b16 v[176:177], v16 offset:16384
  ds_read_b64_tr_b16 v[178:179], v16 offset:18432
  ds_read_b64_tr_b16 v[180:181], v17 offset:16384
  ds_read_b64_tr_b16 v[182:183], v17 offset:18432
  ds_read_b128 v[192:195], v20 offset:4096
  ds_read_b128 v[196:199], v20 offset:20480
  s_waitcnt lgkmcnt(6)
  v_mfma_f32_16x16x32_bf16 v[160:163], v[184:187], v[200:203], v[160:163]
  v_mfma_f32_16x16x32_bf16 v[164:167], v[188:191], v[200:203], v[164:167]
  v_mfma_f32_16x16x32_bf16 v[168:171], v[184:187], v[204:207], v[168:171]
  v_mfma_f32_16x16x32_bf16 v[172:175], v[188:191], v[204:207], v[172:175]
  ds_read_b64_tr_b16 v[184:185], v16 offset:20480
  ds_read_b64_tr_b16 v[186:187], v16 offset:22528
  ds_read_b64_tr_b16 v[188:189], v17 offset:20480
  ds_read_b64_tr_b16 v[190:191], v17 offset:22528
  ds_read_b128 v[200:203], v20 offset:5120
  ds_read_b128 v[204:207], v20 offset:21504
  s_waitcnt lgkmcnt(6)
  v_mfma_f32_16x16x32_bf16 v[160:163], v[176:179], v[192:195], v[160:163]
  v_mfma_f32_16x16x32_bf16 v[164:167], v[180:183], v[192:195], v[164:167]
  v_mfma_f32_16x16x32_bf16 v[168:171], v[176:179], v[196:199], v[168:171]
  v_mfma_f32_16x16x32_bf16 v[172:175], v[180:183], v[196:199], v[172:175]
  ds_read_b64_tr_b16 v[176:177], v16 offset:24576
  ds_read_b64_tr_b16 v[178:179], v16 offset:26624
  ds_read_b64_tr_b16 v[180:181], v17 offset:24576
  ds_read_b64_tr_b16 v[182:183], v17 offset:26624
  ds_read_b128 v[192:195], v20 offset:6144
  ds_read_b128 v[196:199], v20 offset:22528
  s_waitcnt lgkmcnt(6)
  v_mfma_f32_16x16x32_bf16 v[160:163], v[184:187], v[200:203], v[160:163]
  v_mfma_f32_16x16x32_bf16 v[164:167], v[188:191], v[200:203], v[164:167]
  v_mfma_f32_16x16x32_bf16 v[168:171], v[184:187], v[204:207], v[168:171]
  v_mfma_f32_16x16x32_bf16 v[172:175], v[188:191], v[204:207], v[172:175]
  ds_read_b64_tr_b16 v[184:185], v16 offset:28672
  ds_read_b64_tr_b16 v[186:187], v16 offset:30720
  ds_read_b64_tr_b16 v[188:189], v17 offset:28672
  ds_read_b64_tr_b16 v[190:191], v17 offset:30720
  ds_read_b128 v[200:203], v20 offset:7168
  ds_read_b128 v[204:207], v20 offset:23552
  s_waitcnt lgkmcnt(6)
  v_mfma_f32_16x16x32_bf16 v[160:163], v[176:179], v[192:195], v[160:163]
  v_mfma_f32_16x16x32_bf16 v[164:167], v[180:183], v[192:195], v[164:167]
  v_mfma_f32_16x16x32_bf16 v[168:171], v[176:179], v[196:199], v[168:171]
  v_mfma_f32_16x16x32_bf16 v[172:175], v[180:183], v[196:199], v[172:175]
  ds_read_b64_tr_b16 v[176:177], v16 offset:32768
  ds_read_b64_tr_b16 v[178:179], v16 offset:34816
  ds_read_b64_tr_b16 v[180:181], v17 offset:32768
  ds_read_b64_tr_b16 v[182:183], v17 offset:34816
  ds_read_b128 v[192:195], v20 offset:8192
  ds_read_b128 v[196:199], v20 offset:24576
  s_waitcnt lgkmcnt(6)
  v_mfma_f32_16x16x32_bf16 v[160:163], v[184:187], v[200:203], v[160:163]
  v_mfma_f32_16x16x32_bf16 v[164:167], v[188:191], v[200:203], v[164:167]
  v_mfma_f32_16x16x32_bf16 v[168:171], v[184:187], v[204:207], v[168:171]
  v_mfma_f32_16x16x32_bf16 v[172:175], v[188:191], v[204:207], v[172:175]
  ds_read_b64_tr_b16 v[184:185], v16 offset:36864
  ds_read_b64_tr_b16 v[186:187], v16 offset:38912
  ds_read_b64_tr_b16 v[188:189], v17 offset:36864
  ds_read_b64_tr_b16 v[190:191], v17 offset:38912
  ds_read_b128 v[200:203], v20 offset:9216
  ds_read_b128 v[204:207], v20 offset:25600
  s_waitcnt lgkmcnt(6)
  v_mfma_f32_16x16x32_bf16 v[160:163], v[176:179], v[192:195], v[160:163]
  v_mfma_f32_16x16x32_bf16 v[164:167], v[180:183], v[192:195], v[164:167]
  v_mfma_f32_16x16x32_bf16 v[168:171], v[176:179], v[196:199], v[168:171]
  v_mfma_f32_16x16x32_bf16 v[172:175], v[180:183], v[196:199], v[172:175]
  ds_read_b64_tr_b16 v[176:177], v16 offset:40960
  ds_read_b64_tr_b16 v[178:179], v16 offset:43008
  ds_read_b64_tr_b16 v[180:181], v17 offset:40960
  ds_read_b64_tr_b16 v[182:183], v17 offset:43008
  ds_read_b128 v[192:195], v20 offset:10240
  ds_read_b128 v[196:199], v20 offset:26624
  s_waitcnt lgkmcnt(6)
  v_mfma_f32_16x16x32_bf16 v[160:163], v[184:187], v[200:203], v[160:163]
  v_mfma_f32_16x16x32_bf16 v[164:167], v[188:191], v[200:203], v[164:167]
  v_mfma_f32_16x16x32_bf16 v[168:171], v[184:187], v[204:207], v[168:171]
  v_mfma_f32_16x16x32_bf16 v[172:175], v[188:191], v[204:207], v[172:175]
  ds_read_b64_tr_b16 v[184:185], v16 offset:45056
  ds_read_b64_tr_b16 v[186:187], v16 offset:47104
  ds_read_b64_tr_b16 v[188:189], v17 offset:45056
  ds_read_b64_tr_b16 v[190:191], v17 offset:47104
  ds_read_b128 v[200:203], v20 offset:11264
  ds_read_b128 v[204:207], v20 offset:27648
  s_waitcnt lgkmcnt(6)
  v_mfma_f32_16x16x32_bf16 v[160:163], v[176:179], v[192:195], v[160:163]
  v_mfma_f32_16x16x32_bf16 v[164:167], v[180:183], v[192:195], v[164:167]
  v_mfma_f32_16x16x32_bf16 v[168:171], v[176:179], v[196:199], v[168:171]
  v_mfma_f32_16x16x32_bf16 v[172:175], v[180:183], v[196:199], v[172:175]
  ds_read_b64_tr_b16 v[176:177], v16 offset:49152
  ds_read_b64_tr_b16 v[178:179], v16 offset:51200
  ds_read_b64_tr_b16 v[180:181], v17 offset:49152
  ds_read_b64_tr_b16 v[182:183], v17 offset:51200
  ds_read_b128 v[192:195], v20 offset:12288
  ds_read_b128 v[196:199], v20 offset:28672
  s_waitcnt lgkmcnt(6)
  v_mfma_f32_16x16x32_bf16 v[160:163], v[184:187], v[200:203], v[160:163]
  v_mfma_f32_16x16x32_bf16 v[164:167], v[188:191], v[200:203], v[164:167]
  v_mfma_f32_16x16x32_bf16 v[168:171], v[184:187], v[204:207], v[168:171]
  v_mfma_f32_16x16x32_bf16 v[172:175], v[188:191], v[204:207], v[172:175]
  ds_read_b64_tr_b16 v[184:185], v16 offset:53248
  ds_read_b64_tr_b16 v[186:187], v16 offset:55296
  ds_read_b64_tr_b16 v[188:189], v17 offset:53248
  ds_read_b64_tr_b16 v[190:191], v17 offset:55296
  ds_read_b128 v[200:203], v20 offset:13312
  ds_read_b128 v[204:207], v20 offset:29696
  s_waitcnt lgkmcnt(6)
  v_mfma_f32_16x16x32_bf16 v[160:163], v[176:179], v[192:195], v[160:163]
  v_mfma_f32_16x16x32_bf16 v[164:167], v[180:183], v[192:195], v[164:167]
  v_mfma_f32_16x16x32_bf16 v[168:171], v[176:179], v[196:199], v[168:171]
  v_mfma_f32_16x16x32_bf16 v[172:175], v[180:183], v[196:199], v[172:175]
  ds_read_b64_tr_b16 v[176:177], v16 offset:57344
  ds_read_b64_tr_b16 v[178:179], v16 offset:59392
  ds_read_b64_tr_b16 v[180:181], v17 offset:57344
  ds_read_b64_tr_b16 v[182:183], v17 offset:59392
  ds_read_b128 v[192:195], v20 offset:14336
  ds_read_b128 v[196:199], v20 offset:30720
  s_waitcnt lgkmcnt(6)
  v_mfma_f32_16x16x32_bf16 v[160:163], v[184:187], v[200:203], v[160:163]
  v_mfma_f32_16x16x32_bf16 v[164:167], v[188:191], v[200:203], v[164:167]
  v_mfma_f32_16x16x32_bf16 v[168:171], v[184:187], v[204:207], v[168:171]
  v_mfma_f32_16x16x32_bf16 v[172:175], v[188:191], v[204:207], v[172:175]
  ds_read_b64_tr_b16 v[184:185], v16 offset:61440
  ds_read_b64_tr_b16 v[186:187], v16 offset:63488
  ds_read_b64_tr_b16 v[188:189], v17 offset:61440
  ds_read_b64_tr_b16 v[190:191], v17 offset:63488
  ds_read_b128 v[200:203], v20 offset:15360
  ds_read_b128 v[204:207], v20 offset:31744
  s_waitcnt lgkmcnt(6)
  v_mfma_f32_16x16x32_bf16 v[160:163], v[176:179], v[192:195], v[160:163]
  v_mfma_f32_16x16x32_bf16 v[164:167], v[180:183], v[192:195], v[164:167]
  v_mfma_f32_16x16x32_bf16 v[168:171], v[176:179], v[196:199], v[168:171]
  v_mfma_f32_16x16x32_bf16 v[172:175], v[180:183], v[196:199], v[172:175]
  s_waitcnt lgkmcnt(0)
  v_mfma_f32_16x16x32_bf16 v[160:163], v[184:187], v[200:203], v[160:163]
  v_mfma_f32_16x16x32_bf16 v[164:167], v[188:191], v[200:203], v[164:167]
  v_mfma_f32_16x16x32_bf16 v[168:171], v[184:187], v[204:207], v[168:171]
  v_mfma_f32_16x16x32_bf16 v[172:175], v[188:191], v[204:207], v[172:175]
  s_nop 7
  s_nop 1
  v_mov_b32 v4, 0
  v_mov_b32 v5, 0
  v_cvt_pk_bf16_f32 v6, v160, v161
  v_lshlrev_b32 v160, 16, v6
  v_and_b32 v161, 0xffff0000, v6
  v_lshlrev_b32 v6, 16, v152
  v_and_b32 v7, 0xffff0000, v152
  v_add_f32 v160, v160, v6
  v_add_f32 v161, v161, v7
  v_cvt_pk_bf16_f32 v192, v160, v161
  v_cvt_pk_bf16_f32 v6, v162, v163
  v_lshlrev_b32 v162, 16, v6
  v_and_b32 v163, 0xffff0000, v6
  v_lshlrev_b32 v6, 16, v153
  v_and_b32 v7, 0xffff0000, v153
  v_add_f32 v162, v162, v6
  v_add_f32 v163, v163, v7
  v_cvt_pk_bf16_f32 v193, v162, v163
  v_cvt_pk_bf16_f32 v6, v164, v165
  v_lshlrev_b32 v164, 16, v6
  v_and_b32 v165, 0xffff0000, v6
  v_lshlrev_b32 v6, 16, v154
  v_and_b32 v7, 0xffff0000, v154
  v_add_f32 v164, v164, v6
  v_add_f32 v165, v165, v7
  v_cvt_pk_bf16_f32 v194, v164, v165
  v_cvt_pk_bf16_f32 v6, v166, v167
  v_lshlrev_b32 v166, 16, v6
  v_and_b32 v167, 0xffff0000, v6
  v_lshlrev_b32 v6, 16, v155
  v_and_b32 v7, 0xffff0000, v155
  v_add_f32 v166, v166, v6
  v_add_f32 v167, v167, v7
  v_cvt_pk_bf16_f32 v195, v166, v167
  s_mov_b32 s45, 0x3f803f80
  v_dot2_f32_bf16 v4, v192, s45, v4
  v_dot2_f32_bf16 v5, v192, v192, v5
  v_dot2_f32_bf16 v4, v193, s45, v4
  v_dot2_f32_bf16 v5, v193, v193, v5
  v_dot2_f32_bf16 v4, v194, s45, v4
  v_dot2_f32_bf16 v5, v194, v194, v5
  v_dot2_f32_bf16 v4, v195, s45, v4
  v_dot2_f32_bf16 v5, v195, v195, v5
  v_mov_b32 v6, v4
  s_nop 1
  v_permlane16_swap_b32 v4, v6
  v_add_f32 v4, v4, v6
  v_mov_b32 v6, v4
  s_nop 1
  v_permlane32_swap_b32 v4, v6
  v_add_f32 v4, v4, v6
  v_mov_b32 v6, v5
  s_nop 1
  v_permlane16_swap_b32 v5, v6
  v_add_f32 v5, v5, v6
  v_mov_b32 v6, v5
  s_nop 1
  v_permlane32_swap_b32 v5, v6
  v_add_f32 v5, v5, v6
  s_lshr_b32 s6, s5, 1
  s_lshl_b32 s6, s6, 1
  s_lshl_b32 s7, s3, 2
  s_add_u32 s6, s6, s7
  s_add_u32 s6, s6, 0
  s_lshl_b32 s46, s6, 14
  s_lshl_b32 s7, s4, 1
  s_and_b32 s47, s5, 1
  s_add_u32 s7, s7, s47
  s_lshl_b32 s47, s7, 10
  s_add_u32 s46, s46, s47
  s_add_u32 s46, s46, 4194304
  v_lshlrev_b32 v7, 4, v1
  buffer_store_dwordx4 v[192:195], v7, s[12:15], s46 offen
  s_lshl_b32 s6, s6, 11
  s_lshl_b32 s7, s7, 3
  s_add_u32 s6, s6, s7
  s_add_u32 s6, s6, 6291456
  v_lshlrev_b32 v7, 7, v3
  s_mov_b64 exec, 0xffff
  buffer_store_dwordx2 v[4:5], v7, s[12:15], s6 offen
  s_mov_b64 exec, -1
  v_mov_b32 v4, 0
  v_mov_b32 v5, 0
  v_cvt_pk_bf16_f32 v6, v168, v169
  v_lshlrev_b32 v168, 16, v6
  v_and_b32 v169, 0xffff0000, v6
  v_lshlrev_b32 v6, 16, v156
  v_and_b32 v7, 0xffff0000, v156
  v_add_f32 v168, v168, v6
  v_add_f32 v169, v169, v7
  v_cvt_pk_bf16_f32 v196, v168, v169
  v_cvt_pk_bf16_f32 v6, v170, v171
  v_lshlrev_b32 v170, 16, v6
  v_and_b32 v171, 0xffff0000, v6
  v_lshlrev_b32 v6, 16, v157
  v_and_b32 v7, 0xffff0000, v157
  v_add_f32 v170, v170, v6
  v_add_f32 v171, v171, v7
  v_cvt_pk_bf16_f32 v197, v170, v171
  v_cvt_pk_bf16_f32 v6, v172, v173
  v_lshlrev_b32 v172, 16, v6
  v_and_b32 v173, 0xffff0000, v6
  v_lshlrev_b32 v6, 16, v158
  v_and_b32 v7, 0xffff0000, v158
  v_add_f32 v172, v172, v6
  v_add_f32 v173, v173, v7
  v_cvt_pk_bf16_f32 v198, v172, v173
  v_cvt_pk_bf16_f32 v6, v174, v175
  v_lshlrev_b32 v174, 16, v6
  v_and_b32 v175, 0xffff0000, v6
  v_lshlrev_b32 v6, 16, v159
  v_and_b32 v7, 0xffff0000, v159
  v_add_f32 v174, v174, v6
  v_add_f32 v175, v175, v7
  v_cvt_pk_bf16_f32 v199, v174, v175
  s_mov_b32 s45, 0x3f803f80
  v_dot2_f32_bf16 v4, v196, s45, v4
  v_dot2_f32_bf16 v5, v196, v196, v5
  v_dot2_f32_bf16 v4, v197, s45, v4
  v_dot2_f32_bf16 v5, v197, v197, v5
  v_dot2_f32_bf16 v4, v198, s45, v4
  v_dot2_f32_bf16 v5, v198, v198, v5
  v_dot2_f32_bf16 v4, v199, s45, v4
  v_dot2_f32_bf16 v5, v199, v199, v5
  v_mov_b32 v6, v4
  s_nop 1
  v_permlane16_swap_b32 v4, v6
  v_add_f32 v4, v4, v6
  v_mov_b32 v6, v4
  s_nop 1
  v_permlane32_swap_b32 v4, v6
  v_add_f32 v4, v4, v6
  v_mov_b32 v6, v5
  s_nop 1
  v_permlane16_swap_b32 v5, v6
  v_add_f32 v5, v5, v6
  v_mov_b32 v6, v5
  s_nop 1
  v_permlane32_swap_b32 v5, v6
  v_add_f32 v5, v5, v6
  s_lshr_b32 s6, s5, 1
  s_lshl_b32 s6, s6, 1
  s_lshl_b32 s7, s3, 2
  s_add_u32 s6, s6, s7
  s_add_u32 s6, s6, 1
  s_lshl_b32 s46, s6, 14
  s_lshl_b32 s7, s4, 1
  s_and_b32 s47, s5, 1
  s_add_u32 s7, s7, s47
  s_lshl_b32 s47, s7, 10
  s_add_u32 s46, s46, s47
  s_add_u32 s46, s46, 4194304
  v_lshlrev_b32 v7, 4, v1
  buffer_store_dwordx4 v[196:199], v7, s[12:15], s46 offen
  s_lshl_b32 s6, s6, 11
  s_lshl_b32 s7, s7, 3
  s_add_u32 s6, s6, s7
  s_add_u32 s6, s6, 6291456
  v_lshlrev_b32 v7, 7, v3
  s_mov_b64 exec, 0xffff
  buffer_store_dwordx2 v[4:5], v7, s[12:15], s6 offen
  s_mov_b64 exec, -1
k2_kernel_end:
  s_endpgm
.globl k3_kernel
.p2align 8
.type k3_kernel,@function
k3_kernel:
  s_cmp_ge_u32 s2, 224
  s_cbranch_scc1 k3_kernel_end
  s_load_dwordx2 s[38:39], s[0:1], 32
  s_load_dwordx2 s[42:43], s[0:1], 64
  s_and_b32 s6, s2, 7
  s_lshr_b32 s7, s6, 1
  s_lshl_b32 s3, s7, 2
  s_bfe_u32 s7, s2, 0x20003
  s_add_u32 s3, s3, s7
  s_and_b32 s7, s6, 1
  s_mul_i32 s4, s7, 7
  s_lshr_b32 s7, s2, 5
  s_add_u32 s4, s4, s7
  v_and_b32 v1, 63, v0
  v_lshrrev_b32 v4, 6, v0
  v_lshrrev_b32 v2, 4, v1
  v_readfirstlane_b32 s5, v4
  v_and_b32 v3, 15, v1
  s_waitcnt lgkmcnt(0)
  s_lshl_b32 s6, s4, 8
  s_add_u32 s8, s38, s6
  s_addc_u32 s9, s39, 0
  s_sub_u32 s10, 1835008, s6
  s_mov_b32 s11, 0x00020000
  s_mov_b32 s12, s42
  s_mov_b32 s13, s43
  s_mov_b32 s14, 268435456
  s_mov_b32 s15, 0x00020000
  s_and_b32 s6, s5, 1
  s_lshl_b32 s6, s6, 2
  v_mul_u32_u24 v10, 3584, v2
  v_add_u32 v4, s6, v2
  v_bfe_u32 v5, v1, 1, 3
  v_xor_b32 v4, v4, v5
  v_and_b32 v5, 1, v1
  v_lshl_or_b32 v4, v4, 1, v5
  v_lshl_add_u32 v10, v4, 4, v10
  v_lshlrev_b32 v11, 4, v1
  s_lshl_b32 s6, s3, 3
  s_add_u32 s6, s6, s5
  s_lshl_b32 s46, s6, 14
  s_add_u32 s46, s46, 4194304
  s_lshl_b32 s47, s6, 11
  s_add_u32 s47, s47, 6291456
  v_lshlrev_b32 v4, 7, v3
  v_lshl_add_u32 v4, v2, 5, v4
  buffer_load_dwordx4 v[56:59], v4, s[12:15], s47 offen
  buffer_load_dwordx4 v[60:63], v4, s[12:15], s47 offen offset:16
  s_lshl_b32 s44, s5, 10
  s_mul_i32 s45, s5, 14336
  s_add_u32 m0, s44, 0
  s_add_u32 s7, s45, 0
  buffer_load_dwordx4 v10, s[8:11], s7 offen lds
  s_add_u32 s48, s46, 0
  buffer_load_dwordx4 v[120:123], v11, s[12:15], s48 offen
  s_add_u32 m0, s44, 8192
  s_add_u32 s7, s45, 114688
  buffer_load_dwordx4 v10, s[8:11], s7 offen lds
  s_add_u32 s48, s46, 1024
  buffer_load_dwordx4 v[124:127], v11, s[12:15], s48 offen
  s_add_u32 m0, s44, 16384
  s_add_u32 s7, s45, 229376
  buffer_load_dwordx4 v10, s[8:11], s7 offen lds
  s_add_u32 s48, s46, 2048
  buffer_load_dwordx4 v[128:131], v11, s[12:15], s48 offen
  s_add_u32 m0, s44, 24576
  s_add_u32 s7, s45, 344064
  buffer_load_dwordx4 v10, s[8:11], s7 offen lds
  s_add_u32 s48, s46, 3072
  buffer_load_dwordx4 v[132:135], v11, s[12:15], s48 offen
  s_add_u32 m0, s44, 32768
  s_add_u32 s7, s45, 458752
  buffer_load_dwordx4 v10, s[8:11], s7 offen lds
  s_add_u32 s48, s46, 4096
  buffer_load_dwordx4 v[136:139], v11, s[12:15], s48 offen
  s_add_u32 m0, s44, 40960
  s_add_u32 s7, s45, 573440
  buffer_load_dwordx4 v10, s[8:11], s7 offen lds
  s_add_u32 s48, s46, 5120
  buffer_load_dwordx4 v[140:143], v11, s[12:15], s48 offen
  s_add_u32 m0, s44, 49152
  s_add_u32 s7, s45, 688128
  buffer_load_dwordx4 v10, s[8:11], s7 offen lds
  s_add_u32 s48, s46, 6144
  buffer_load_dwordx4 v[144:147], v11, s[12:15], s48 offen
  s_add_u32 m0, s44, 57344
  s_add_u32 s7, s45, 802816
  buffer_load_dwordx4 v10, s[8:11], s7 offen lds
  s_add_u32 s48, s46, 7168
  buffer_load_dwordx4 v[148:151], v11, s[12:15], s48 offen
  v_bfe_u32 v4, v1, 2, 2
  v_lshl_add_u32 v5, v2, 2, v4
  v_lshlrev_b32 v6, 8, v5
  v_and_b32 v7, 3, v1
  v_lshl_add_u32 v6, v7, 3, v6
  v_and_b32 v5, 7, v5
  v_xor_b32 v7, 0, v5
  v_lshl_add_u32 v16, v7, 5, v6
  v_xor_b32 v7, 1, v5
  v_lshl_add_u32 v17, v7, 5, v6
  v_xor_b32 v7, 2, v5
  v_lshl_add_u32 v18, v7, 5, v6
  v_xor_b32 v7, 3, v5
  v_lshl_add_u32 v19, v7, 5, v6
  v_xor_b32 v7, 4, v5
  v_lshl_add_u32 v20, v7, 5, v6
  v_xor_b32 v7, 5, v5
  v_lshl_add_u32 v21, v7, 5, v6
  v_xor_b32 v7, 6, v5
  v_lshl_add_u32 v22, v7, 5, v6
  v_xor_b32 v7, 7, v5
  v_lshl_add_u32 v23, v7, 5, v6
  s_waitcnt vmcnt(16)
  v_add_f32 v56, v56, v58
  v_add_f32 v57, v57, v59
  v_add_f32 v60, v60, v62
  v_add_f32 v61, v61, v63
  v_add_f32 v56, v56, v60
  v_add_f32 v57, v57, v61
  v_mov_b32 v4, v56
  s_nop 1
  v_permlane16_swap_b32 v56, v4
  v_add_f32 v56, v56, v4
  v_mov_b32 v4, v56
  s_nop 1
  v_permlane32_swap_b32 v56, v4
  v_add_f32 v56, v56, v4
  v_mov_b32 v4, v57
  s_nop 1
  v_permlane16_swap_b32 v57, v4
  v_add_f32 v57, v57, v4
  v_mov_b32 v4, v57
  s_nop 1
  v_permlane32_swap_b32 v57, v4
  v_add_f32 v57, v57, v4
  v_mul_f32 v12, 0x3b000000, v56
  v_mul_f32 v4, 0x3b000000, v57
  v_fma_f32 v4, -v12, v12, v4
  v_max_f32 v4, 0, v4
  v_cvt_pk_bf16_f32 v12, v12, v12
  v_lshlrev_b32 v12, 16, v12
  v_cvt_pk_bf16_f32 v4, v4, v4
  v_lshlrev_b32 v4, 16, v4
  v_add_f32 v4, 0x3727c5ac, v4
  v_cvt_pk_bf16_f32 v4, v4, v4
  v_lshlrev_b32 v4, 16, v4
  v_sqrt_f32 v4, v4
  s_nop 0
  v_cvt_pk_bf16_f32 v4, v4, v4
  v_lshlrev_b32 v4, 16, v4
  v_rcp_f32 v13, v4
  s_nop 0
  v_sub_f32 v12, 0, v12
  s_waitcnt vmcnt(8)
  s_barrier
  ds_read_b64_tr_b16 v[56:57], v16 offset:0
  ds_read_b64_tr_b16 v[58:59], v16 offset:4096
  ds_read_b64_tr_b16 v[60:61], v17 offset:0
  ds_read_b64_tr_b16 v[62:63], v17 offset:4096
  ds_read_b64_tr_b16 v[64:65], v18 offset:0
  ds_read_b64_tr_b16 v[66:67], v18 offset:4096
  ds_read_b64_tr_b16 v[68:69], v19 offset:0
  ds_read_b64_tr_b16 v[70:71], v19 offset:4096
  ds_read_b64_tr_b16 v[72:73], v20 offset:0
  ds_read_b64_tr_b16 v[74:75], v20 offset:4096
  ds_read_b64_tr_b16 v[76:77], v21 offset:0
  ds_read_b64_tr_b16 v[78:79], v21 offset:4096
  ds_read_b64_tr_b16 v[80:81], v22 offset:0
  ds_read_b64_tr_b16 v[82:83], v22 offset:4096
  ds_read_b64_tr_b16 v[84:85], v23 offset:0
  ds_read_b64_tr_b16 v[86:87], v23 offset:4096
  v_lshlrev_b32 v4, 16, v120
  v_and_b32 v5, 0xffff0000, v120
  v_pk_add_f32 v[4:5], v[4:5], v[12:13] op_sel_hi:[1,0]
  v_cvt_pk_bf16_f32 v120, v4, v5
  v_lshlrev_b32 v6, 16, v121
  v_and_b32 v7, 0xffff0000, v121
  v_pk_add_f32 v[6:7], v[6:7], v[12:13] op_sel_hi:[1,0]
  v_cvt_pk_bf16_f32 v121, v6, v7
  v_lshlrev_b32 v8, 16, v122
  v_and_b32 v9, 0xffff0000, v122
  v_pk_add_f32 v[8:9], v[8:9], v[12:13] op_sel_hi:[1,0]
  v_cvt_pk_bf16_f32 v122, v8, v9
  v_lshlrev_b32 v4, 16, v123
  v_and_b32 v5, 0xffff0000, v123
  v_pk_add_f32 v[4:5], v[4:5], v[12:13] op_sel_hi:[1,0]
  v_cvt_pk_bf16_f32 v123, v4, v5
  s_waitcnt lgkmcnt(0)
  s_nop 1
  v_mfma_f32_16x16x32_bf16 v[24:27], v[56:59], v[120:123], 0
  ds_read_b64_tr_b16 v[88:89], v16 offset:8192
  ds_read_b64_tr_b16 v[90:91], v16 offset:12288
  ds_read_b64_tr_b16 v[92:93], v17 offset:8192
  v_mfma_f32_16x16x32_bf16 v[28:31], v[60:63], v[120:123], 0
  ds_read_b64_tr_b16 v[94:95], v17 offset:12288
  v_lshlrev_b32 v4, 16, v124
  v_and_b32 v5, 0xffff0000, v124
  v_pk_add_f32 v[4:5], v[4:5], v[12:13] op_sel_hi:[1,0]
  v_cvt_pk_bf16_f32 v124, v4, v5
  ds_read_b64_tr_b16 v[96:97], v18 offset:8192
  v_mfma_f32_16x16x32_bf16 v[32:35], v[64:67], v[120:123], 0
  s_add_u32 m0, s44, 65536
  s_add_u32 s7, s45, 917504
  buffer_load_dwordx4 v10, s[8:11], s7 offen lds
  ds_read_b64_tr_b16 v[98:99], v18 offset:12288
  ds_read_b64_tr_b16 v[100:101], v19 offset:8192
  v_mfma_f32_16x16x32_bf16 v[36:39], v[68:71], v[120:123], 0
  ds_read_b64_tr_b16 v[102:103], v19 offset:12288
  v_lshlrev_b32 v6, 16, v125
  v_and_b32 v7, 0xffff0000, v125
  v_pk_add_f32 v[6:7], v[6:7], v[12:13] op_sel_hi:[1,0]
  v_cvt_pk_bf16_f32 v125, v6, v7
  ds_read_b64_tr_b16 v[104:105], v20 offset:8192
  v_mfma_f32_16x16x32_bf16 v[40:43], v[72:75], v[120:123], 0
  ds_read_b64_tr_b16 v[106:107], v20 offset:12288
  s_add_u32 s48, s46, 8192
  buffer_load_dwordx4 v[152:155], v11, s[12:15], s48 offen
  ds_read_b64_tr_b16 v[108:109], v21 offset:8192
  v_mfma_f32_16x16x32_bf16 v[44:47], v[76:79], v[120:123], 0
  ds_read_b64_tr_b16 v[110:111], v21 offset:12288
  v_lshlrev_b32 v8, 16, v126
  v_and_b32 v9, 0xffff0000, v126
  v_pk_add_f32 v[8:9], v[8:9], v[12:13] op_sel_hi:[1,0]
  v_cvt_pk_bf16_f32 v126, v8, v9
  ds_read_b64_tr_b16 v[112:113], v22 offset:8192
  v_mfma_f32_16x16x32_bf16 v[48:51], v[80:83], v[120:123], 0
  ds_read_b64_tr_b16 v[114:115], v22 offset:12288
  ds_read_b64_tr_b16 v[116:117], v23 offset:8192
  s_add_u32 m0, s44, 73728
  s_add_u32 s7, s45, 1032192
  buffer_load_dwordx4 v10, s[8:11], s7 offen lds
  v_mfma_f32_16x16x32_bf16 v[52:55], v[84:87], v[120:123], 0
  ds_read_b64_tr_b16 v[118:119], v23 offset:12288
  v_lshlrev_b32 v4, 16, v127
  v_and_b32 v5, 0xffff0000, v127
  v_pk_add_f32 v[4:5], v[4:5], v[12:13] op_sel_hi:[1,0]
  v_cvt_pk_bf16_f32 v127, v4, v5
  s_waitcnt lgkmcnt(0)
  s_nop 1
  v_mfma_f32_16x16x32_bf16 v[24:27], v[88:91], v[124:127], v[24:27]
  ds_read_b64_tr_b16 v[56:57], v16 offset:16384
  ds_read_b64_tr_b16 v[58:59], v16 offset:20480
  ds_read_b64_tr_b16 v[60:61], v17 offset:16384
  v_mfma_f32_16x16x32_bf16 v[28:31], v[92:95], v[124:127], v[28:31]
  ds_read_b64_tr_b16 v[62:63], v17 offset:20480
  v_lshlrev_b32 v4, 16, v128
  v_and_b32 v5, 0xffff0000, v128
  v_pk_add_f32 v[4:5], v[4:5], v[12:13] op_sel_hi:[1,0]
  v_cvt_pk_bf16_f32 v128, v4, v5
  ds_read_b64_tr_b16 v[64:65], v18 offset:16384
  v_mfma_f32_16x16x32_bf16 v[32:35], v[96:99], v[124:127], v[32:35]
  s_add_u32 s48, s46, 9216
  buffer_load_dwordx4 v[156:159], v11, s[12:15], s48 offen
  ds_read_b64_tr_b16 v[66:67], v18 offset:20480
  ds_read_b64_tr_b16 v[68:69], v19 offset:16384
  v_mfma_f32_16x16x32_bf16 v[36:39], v[100:103], v[124:127], v[36:39]
  ds_read_b64_tr_b16 v[70:71], v19 offset:20480
  v_lshlrev_b32 v6, 16, v129
  v_and_b32 v7, 0xffff0000, v129
  v_pk_add_f32 v[6:7], v[6:7], v[12:13] op_sel_hi:[1,0]
  v_cvt_pk_bf16_f32 v129, v6, v7
  ds_read_b64_tr_b16 v[72:73], v20 offset:16384
  v_mfma_f32_16x16x32_bf16 v[40:43], v[104:107], v[124:127], v[40:43]
  ds_read_b64_tr_b16 v[74:75], v20 offset:20480
  s_add_u32 m0, s44, 81920
  s_add_u32 s7, s45, 1146880
  buffer_load_dwordx4 v10, s[8:11], s7 offen lds
  ds_read_b64_tr_b16 v[76:77], v21 offset:16384
  v_mfma_f32_16x16x32_bf16 v[44:47], v[108:111], v[124:127], v[44:47]
  ds_read_b64_tr_b16 v[78:79], v21 offset:20480
  v_lshlrev_b32 v8, 16, v130
  v_and_b32 v9, 0xffff0000, v130
  v_pk_add_f32 v[8:9], v[8:9], v[12:13] op_sel_hi:[1,0]
  v_cvt_pk_bf16_f32 v130, v8, v9
  ds_read_b64_tr_b16 v[80:81], v22 offset:16384
  v_mfma_f32_16x16x32_bf16 v[48:51], v[112:115], v[124:127], v[48:51]
  ds_read_b64_tr_b16 v[82:83], v22 offset:20480
  ds_read_b64_tr_b16 v[84:85], v23 offset:16384
  s_add_u32 s48, s46, 10240
  buffer_load_dwordx4 v[160:163], v11, s[12:15], s48 offen
  v_mfma_f32_16x16x32_bf16 v[52:55], v[116:119], v[124:127], v[52:55]
  ds_read_b64_tr_b16 v[86:87], v23 offset:20480
  v_lshlrev_b32 v4, 16, v131
  v_and_b32 v5, 0xffff0000, v131
  v_pk_add_f32 v[4:5], v[4:5], v[12:13] op_sel_hi:[1,0]
  v_cvt_pk_bf16_f32 v131, v4, v5
  s_waitcnt lgkmcnt(0)
  s_nop 1
  v_mfma_f32_16x16x32_bf16 v[24:27], v[56:59], v[128:131], v[24:27]
  ds_read_b64_tr_b16 v[88:89], v16 offset:24576
  ds_read_b64_tr_b16 v[90:91], v16 offset:28672
  ds_read_b64_tr_b16 v[92:93], v17 offset:24576
  v_mfma_f32_16x16x32_bf16 v[28:31], v[60:63], v[128:131], v[28:31]
  ds_read_b64_tr_b16 v[94:95], v17 offset:28672
  v_lshlrev_b32 v4, 16, v132
  v_and_b32 v5, 0xffff0000, v132
  v_pk_add_f32 v[4:5], v[4:5], v[12:13] op_sel_hi:[1,0]
  v_cvt_pk_bf16_f32 v132, v4, v5
  ds_read_b64_tr_b16 v[96:97], v18 offset:24576
  v_mfma_f32_16x16x32_bf16 v[32:35], v[64:67], v[128:131], v[32:35]
  s_add_u32 m0, s44, 90112
  s_add_u32 s7, s45, 1261568
  buffer_load_dwordx4 v10, s[8:11], s7 offen lds
  ds_read_b64_tr_b16 v[98:99], v18 offset:28672
  ds_read_b64_tr_b16 v[100:101], v19 offset:24576
  v_mfma_f32_16x16x32_bf16 v[36:39], v[68:71], v[128:131], v[36:39]
  ds_read_b64_tr_b16 v[102:103], v19 offset:28672
  v_lshlrev_b32 v6, 16, v133
  v_and_b32 v7, 0xffff0000, v133
  v_pk_add_f32 v[6:7], v[6:7], v[12:13] op_sel_hi:[1,0]
  v_cvt_pk_bf16_f32 v133, v6, v7
  v_mfma_f32_16x16x32_bf16 v[40:43], v[72:75], v[128:131], v[40:43]
  ds_read_b64_tr_b16 v[104:105], v20 offset:24576
  ds_read_b64_tr_b16 v[106:107], v20 offset:28672
  s_add_u32 s48, s46, 11264
  buffer_load_dwordx4 v[164:167], v11, s[12:15], s48 offen
  v_mfma_f32_16x16x32_bf16 v[44:47], v[76:79], v[128:131], v[44:47]
  ds_read_b64_tr_b16 v[108:109], v21 offset:24576
  ds_read_b64_tr_b16 v[110:111], v21 offset:28672
  v_lshlrev_b32 v8, 16, v134
  v_and_b32 v9, 0xffff0000, v134
  v_pk_add_f32 v[8:9], v[8:9], v[12:13] op_sel_hi:[1,0]
  v_cvt_pk_bf16_f32 v134, v8, v9
  v_mfma_f32_16x16x32_bf16 v[48:51], v[80:83], v[128:131], v[48:51]
  ds_read_b64_tr_b16 v[112:113], v22 offset:24576
  ds_read_b64_tr_b16 v[114:115], v22 offset:28672
  ds_read_b64_tr_b16 v[116:117], v23 offset:24576
  v_mfma_f32_16x16x32_bf16 v[52:55], v[84:87], v[128:131], v[52:55]
  ds_read_b64_tr_b16 v[118:119], v23 offset:28672
  v_lshlrev_b32 v4, 16, v135
  v_and_b32 v5, 0xffff0000, v135
  v_pk_add_f32 v[4:5], v[4:5], v[12:13] op_sel_hi:[1,0]
  v_cvt_pk_bf16_f32 v135, v4, v5
  s_waitcnt vmcnt(8)
  s_barrier
  s_waitcnt lgkmcnt(0)
  s_nop 1
  v_mfma_f32_16x16x32_bf16 v[24:27], v[88:91], v[132:135], v[24:27]
  ds_read_b64_tr_b16 v[56:57], v16 offset:32768
  ds_read_b64_tr_b16 v[58:59], v16 offset:36864
  ds_read_b64_tr_b16 v[60:61], v17 offset:32768
  v_mfma_f32_16x16x32_bf16 v[28:31], v[92:95], v[132:135], v[28:31]
  ds_read_b64_tr_b16 v[62:63], v17 offset:36864
  v_lshlrev_b32 v4, 16, v136
  v_and_b32 v5, 0xffff0000, v136
  v_pk_add_f32 v[4:5], v[4:5], v[12:13] op_sel_hi:[1,0]
  v_cvt_pk_bf16_f32 v136, v4, v5
  ds_read_b64_tr_b16 v[64:65], v18 offset:32768
  v_mfma_f32_16x16x32_bf16 v[32:35], v[96:99], v[132:135], v[32:35]
  s_add_u32 m0, s44, 98304
  s_add_u32 s7, s45, 1376256
  buffer_load_dwordx4 v10, s[8:11], s7 offen lds
  ds_read_b64_tr_b16 v[66:67], v18 offset:36864
  ds_read_b64_tr_b16 v[68:69], v19 offset:32768
  v_mfma_f32_16x16x32_bf16 v[36:39], v[100:103], v[132:135], v[36:39]
  ds_read_b64_tr_b16 v[70:71], v19 offset:36864
  v_lshlrev_b32 v6, 16, v137
  v_and_b32 v7, 0xffff0000, v137
  v_pk_add_f32 v[6:7], v[6:7], v[12:13] op_sel_hi:[1,0]
  v_cvt_pk_bf16_f32 v137, v6, v7
  ds_read_b64_tr_b16 v[72:73], v20 offset:32768
  v_mfma_f32_16x16x32_bf16 v[40:43], v[104:107], v[132:135], v[40:43]
  ds_read_b64_tr_b16 v[74:75], v20 offset:36864
  s_add_u32 s48, s46, 12288
  buffer_load_dwordx4 v[120:123], v11, s[12:15], s48 offen
  ds_read_b64_tr_b16 v[76:77], v21 offset:32768
  v_mfma_f32_16x16x32_bf16 v[44:47], v[108:111], v[132:135], v[44:47]
  ds_read_b64_tr_b16 v[78:79], v21 offset:36864
  v_lshlrev_b32 v8, 16, v138
  v_and_b32 v9, 0xffff0000, v138
  v_pk_add_f32 v[8:9], v[8:9], v[12:13] op_sel_hi:[1,0]
  v_cvt_pk_bf16_f32 v138, v8, v9
  ds_read_b64_tr_b16 v[80:81], v22 offset:32768
  v_mfma_f32_16x16x32_bf16 v[48:51], v[112:115], v[132:135], v[48:51]
  ds_read_b64_tr_b16 v[82:83], v22 offset:36864
  ds_read_b64_tr_b16 v[84:85], v23 offset:32768
  s_add_u32 m0, s44, 106496
  s_add_u32 s7, s45, 1490944
  buffer_load_dwordx4 v10, s[8:11], s7 offen lds
  v_mfma_f32_16x16x32_bf16 v[52:55], v[116:119], v[132:135], v[52:55]
  ds_read_b64_tr_b16 v[86:87], v23 offset:36864
  v_lshlrev_b32 v4, 16, v139
  v_and_b32 v5, 0xffff0000, v139
  v_pk_add_f32 v[4:5], v[4:5], v[12:13] op_sel_hi:[1,0]
  v_cvt_pk_bf16_f32 v139, v4, v5
  s_waitcnt lgkmcnt(0)
  s_nop 1
  v_mfma_f32_16x16x32_bf16 v[24:27], v[56:59], v[136:139], v[24:27]
  ds_read_b64_tr_b16 v[88:89], v16 offset:40960
  ds_read_b64_tr_b16 v[90:91], v16 offset:45056
  ds_read_b64_tr_b16 v[92:93], v17 offset:40960
  v_mfma_f32_16x16x32_bf16 v[28:31], v[60:63], v[136:139], v[28:31]
  ds_read_b64_tr_b16 v[94:95], v17 offset:45056
  v_lshlrev_b32 v4, 16, v140
  v_and_b32 v5, 0xffff0000, v140
  v_pk_add_f32 v[4:5], v[4:5], v[12:13] op_sel_hi:[1,0]
  v_cvt_pk_bf16_f32 v140, v4, v5
  ds_read_b64_tr_b16 v[96:97], v18 offset:40960
  v_mfma_f32_16x16x32_bf16 v[32:35], v[64:67], v[136:139], v[32:35]
  s_add_u32 s48, s46, 13312
  buffer_load_dwordx4 v[124:127], v11, s[12:15], s48 offen
  ds_read_b64_tr_b16 v[98:99], v18 offset:45056
  ds_read_b64_tr_b16 v[100:101], v19 offset:40960
  v_mfma_f32_16x16x32_bf16 v[36:39], v[68:71], v[136:139], v[36:39]
  ds_read_b64_tr_b16 v[102:103], v19 offset:45056
  v_lshlrev_b32 v6, 16, v141
  v_and_b32 v7, 0xffff0000, v141
  v_pk_add_f32 v[6:7], v[6:7], v[12:13] op_sel_hi:[1,0]
  v_cvt_pk_bf16_f32 v141, v6, v7
  ds_read_b64_tr_b16 v[104:105], v20 offset:40960
  v_mfma_f32_16x16x32_bf16 v[40:43], v[72:75], v[136:139], v[40:43]
  ds_read_b64_tr_b16 v[106:107], v20 offset:45056
  s_add_u32 m0, s44, 114688
  s_add_u32 s7, s45, 1605632
  buffer_load_dwordx4 v10, s[8:11], s7 offen lds
  ds_read_b64_tr_b16 v[108:109], v21 offset:40960
  v_mfma_f32_16x16x32_bf16 v[44:47], v[76:79], v[136:139], v[44:47]
  ds_read_b64_tr_b16 v[110:111], v21 offset:45056
  v_lshlrev_b32 v8, 16, v142
  v_and_b32 v9, 0xffff0000, v142
  v_pk_add_f32 v[8:9], v[8:9], v[12:13] op_sel_hi:[1,0]
  v_cvt_pk_bf16_f32 v142, v8, v9
  ds_read_b64_tr_b16 v[112:113], v22 offset:40960
  v_mfma_f32_16x16x32_bf16 v[48:51], v[80:83], v[136:139], v[48:51]
  ds_read_b64_tr_b16 v[114:115], v22 offset:45056
  ds_read_b64_tr_b16 v[116:117], v23 offset:40960
  s_add_u32 s48, s46, 14336
  buffer_load_dwordx4 v[128:131], v11, s[12:15], s48 offen
  v_mfma_f32_16x16x32_bf16 v[52:55], v[84:87], v[136:139], v[52:55]
  ds_read_b64_tr_b16 v[118:119], v23 offset:45056
  v_lshlrev_b32 v4, 16, v143
  v_and_b32 v5, 0xffff0000, v143
  v_pk_add_f32 v[4:5], v[4:5], v[12:13] op_sel_hi:[1,0]
  v_cvt_pk_bf16_f32 v143, v4, v5
  s_waitcnt lgkmcnt(0)
  s_nop 1
  v_mfma_f32_16x16x32_bf16 v[24:27], v[88:91], v[140:143], v[24:27]
  ds_read_b64_tr_b16 v[56:57], v16 offset:49152
  ds_read_b64_tr_b16 v[58:59], v16 offset:53248
  ds_read_b64_tr_b16 v[60:61], v17 offset:49152
  v_mfma_f32_16x16x32_bf16 v[28:31], v[92:95], v[140:143], v[28:31]
  ds_read_b64_tr_b16 v[62:63], v17 offset:53248
  v_lshlrev_b32 v4, 16, v144
  v_and_b32 v5, 0xffff0000, v144
  v_pk_add_f32 v[4:5], v[4:5], v[12:13] op_sel_hi:[1,0]
  v_cvt_pk_bf16_f32 v144, v4, v5
  ds_read_b64_tr_b16 v[64:65], v18 offset:49152
  v_mfma_f32_16x16x32_bf16 v[32:35], v[96:99], v[140:143], v[32:35]
  s_add_u32 m0, s44, 122880
  s_add_u32 s7, s45, 1720320
  buffer_load_dwordx4 v10, s[8:11], s7 offen lds
  ds_read_b64_tr_b16 v[66:67], v18 offset:53248
  ds_read_b64_tr_b16 v[68:69], v19 offset:49152
  v_mfma_f32_16x16x32_bf16 v[36:39], v[100:103], v[140:143], v[36:39]
  ds_read_b64_tr_b16 v[70:71], v19 offset:53248
  v_lshlrev_b32 v6, 16, v145
  v_and_b32 v7, 0xffff0000, v145
  v_pk_add_f32 v[6:7], v[6:7], v[12:13] op_sel_hi:[1,0]
  v_cvt_pk_bf16_f32 v145, v6, v7
  v_mfma_f32_16x16x32_bf16 v[40:43], v[104:107], v[140:143], v[40:43]
  ds_read_b64_tr_b16 v[72:73], v20 offset:49152
  ds_read_b64_tr_b16 v[74:75], v20 offset:53248
  s_add_u32 s48, s46, 15360
  buffer_load_dwordx4 v[132:135], v11, s[12:15], s48 offen
  v_mfma_f32_16x16x32_bf16 v[44:47], v[108:111], v[140:143], v[44:47]
  ds_read_b64_tr_b16 v[76:77], v21 offset:49152
  ds_read_b64_tr_b16 v[78:79], v21 offset:53248
  v_lshlrev_b32 v8, 16, v146
  v_and_b32 v9, 0xffff0000, v146
  v_pk_add_f32 v[8:9], v[8:9], v[12:13] op_sel_hi:[1,0]
  v_cvt_pk_bf16_f32 v146, v8, v9
  v_mfma_f32_16x16x32_bf16 v[48:51], v[112:115], v[140:143], v[48:51]
  ds_read_b64_tr_b16 v[80:81], v22 offset:49152
  ds_read_b64_tr_b16 v[82:83], v22 offset:53248
  ds_read_b64_tr_b16 v[84:85], v23 offset:49152
  v_mfma_f32_16x16x32_bf16 v[52:55], v[116:119], v[140:143], v[52:55]
  ds_read_b64_tr_b16 v[86:87], v23 offset:53248
  v_lshlrev_b32 v4, 16, v147
  v_and_b32 v5, 0xffff0000, v147
  v_pk_add_f32 v[4:5], v[4:5], v[12:13] op_sel_hi:[1,0]
  v_cvt_pk_bf16_f32 v147, v4, v5
  s_waitcnt lgkmcnt(0)
  s_nop 1
  v_mfma_f32_16x16x32_bf16 v[24:27], v[56:59], v[144:147], v[24:27]
  ds_read_b64_tr_b16 v[88:89], v16 offset:57344
  ds_read_b64_tr_b16 v[90:91], v16 offset:61440
  ds_read_b64_tr_b16 v[92:93], v17 offset:57344
  v_mfma_f32_16x16x32_bf16 v[28:31], v[60:63], v[144:147], v[28:31]
  ds_read_b64_tr_b16 v[94:95], v17 offset:61440
  v_lshlrev_b32 v4, 16, v148
  v_and_b32 v5, 0xffff0000, v148
  v_pk_add_f32 v[4:5], v[4:5], v[12:13] op_sel_hi:[1,0]
  v_cvt_pk_bf16_f32 v148, v4, v5
  v_mfma_f32_16x16x32_bf16 v[32:35], v[64:67], v[144:147], v[32:35]
  ds_read_b64_tr_b16 v[96:97], v18 offset:57344
  ds_read_b64_tr_b16 v[98:99], v18 offset:61440
  ds_read_b64_tr_b16 v[100:101], v19 offset:57344
  v_mfma_f32_16x16x32_bf16 v[36:39], v[68:71], v[144:147], v[36:39]
  ds_read_b64_tr_b16 v[102:103], v19 offset:61440
  v_lshlrev_b32 v6, 16, v149
  v_and_b32 v7, 0xffff0000, v149
  v_pk_add_f32 v[6:7], v[6:7], v[12:13] op_sel_hi:[1,0]
  v_cvt_pk_bf16_f32 v149, v6, v7
  v_mfma_f32_16x16x32_bf16 v[40:43], v[72:75], v[144:147], v[40:43]
  ds_read_b64_tr_b16 v[104:105], v20 offset:57344
  ds_read_b64_tr_b16 v[106:107], v20 offset:61440
  ds_read_b64_tr_b16 v[108:109], v21 offset:57344
  v_mfma_f32_16x16x32_bf16 v[44:47], v[76:79], v[144:147], v[44:47]
  ds_read_b64_tr_b16 v[110:111], v21 offset:61440
  v_lshlrev_b32 v8, 16, v150
  v_and_b32 v9, 0xffff0000, v150
  v_pk_add_f32 v[8:9], v[8:9], v[12:13] op_sel_hi:[1,0]
  v_cvt_pk_bf16_f32 v150, v8, v9
  v_mfma_f32_16x16x32_bf16 v[48:51], v[80:83], v[144:147], v[48:51]
  ds_read_b64_tr_b16 v[112:113], v22 offset:57344
  ds_read_b64_tr_b16 v[114:115], v22 offset:61440
  ds_read_b64_tr_b16 v[116:117], v23 offset:57344
  v_mfma_f32_16x16x32_bf16 v[52:55], v[84:87], v[144:147], v[52:55]
  ds_read_b64_tr_b16 v[118:119], v23 offset:61440
  v_lshlrev_b32 v4, 16, v151
  v_and_b32 v5, 0xffff0000, v151
  v_pk_add_f32 v[4:5], v[4:5], v[12:13] op_sel_hi:[1,0]
  v_cvt_pk_bf16_f32 v151, v4, v5
  s_waitcnt vmcnt(8)
  s_barrier
  s_waitcnt lgkmcnt(0)
  s_nop 1
  v_mfma_f32_16x16x32_bf16 v[24:27], v[88:91], v[148:151], v[24:27]
  v_add_u32 v16, 0x10000, v16
  v_add_u32 v17, 0x10000, v17
  v_add_u32 v18, 0x10000, v18
  v_add_u32 v19, 0x10000, v19
  v_mfma_f32_16x16x32_bf16 v[28:31], v[92:95], v[148:151], v[28:31]
  v_lshlrev_b32 v4, 16, v152
  v_and_b32 v5, 0xffff0000, v152
  v_pk_add_f32 v[4:5], v[4:5], v[12:13] op_sel_hi:[1,0]
  v_cvt_pk_bf16_f32 v152, v4, v5
  v_add_u32 v20, 0x10000, v20
  v_add_u32 v21, 0x10000, v21
  v_mfma_f32_16x16x32_bf16 v[32:35], v[96:99], v[148:151], v[32:35]
  v_add_u32 v22, 0x10000, v22
  v_add_u32 v23, 0x10000, v23
  v_lshlrev_b32 v6, 16, v153
  v_and_b32 v7, 0xffff0000, v153
  v_pk_add_f32 v[6:7], v[6:7], v[12:13] op_sel_hi:[1,0]
  v_cvt_pk_bf16_f32 v153, v6, v7
  ds_read_b64_tr_b16 v[56:57], v16 offset:0
  v_mfma_f32_16x16x32_bf16 v[36:39], v[100:103], v[148:151], v[36:39]
  ds_read_b64_tr_b16 v[58:59], v16 offset:4096
  ds_read_b64_tr_b16 v[60:61], v17 offset:0
  ds_read_b64_tr_b16 v[62:63], v17 offset:4096
  v_mfma_f32_16x16x32_bf16 v[40:43], v[104:107], v[148:151], v[40:43]
  v_lshlrev_b32 v8, 16, v154
  v_and_b32 v9, 0xffff0000, v154
  v_pk_add_f32 v[8:9], v[8:9], v[12:13] op_sel_hi:[1,0]
  v_cvt_pk_bf16_f32 v154, v8, v9
  ds_read_b64_tr_b16 v[64:65], v18 offset:0
  ds_read_b64_tr_b16 v[66:67], v18 offset:4096
  ds_read_b64_tr_b16 v[68:69], v19 offset:0
  v_mfma_f32_16x16x32_bf16 v[44:47], v[108:111], v[148:151], v[44:47]
  ds_read_b64_tr_b16 v[70:71], v19 offset:4096
  v_lshlrev_b32 v4, 16, v155
  v_and_b32 v5, 0xffff0000, v155
  v_pk_add_f32 v[4:5], v[4:5], v[12:13] op_sel_hi:[1,0]
  v_cvt_pk_bf16_f32 v155, v4, v5
  ds_read_b64_tr_b16 v[72:73], v20 offset:0
  v_mfma_f32_16x16x32_bf16 v[48:51], v[112:115], v[148:151], v[48:51]
  ds_read_b64_tr_b16 v[74:75], v20 offset:4096
  ds_read_b64_tr_b16 v[76:77], v21 offset:0
  ds_read_b64_tr_b16 v[78:79], v21 offset:4096
  ds_read_b64_tr_b16 v[80:81], v22 offset:0
  v_mfma_f32_16x16x32_bf16 v[52:55], v[116:119], v[148:151], v[52:55]
  ds_read_b64_tr_b16 v[82:83], v22 offset:4096
  ds_read_b64_tr_b16 v[84:85], v23 offset:0
  ds_read_b64_tr_b16 v[86:87], v23 offset:4096
  s_waitcnt lgkmcnt(0)
  s_nop 1
  v_mfma_f32_16x16x32_bf16 v[24:27], v[56:59], v[152:155], v[24:27]
  ds_read_b64_tr_b16 v[88:89], v16 offset:8192
  ds_read_b64_tr_b16 v[90:91], v16 offset:12288
  ds_read_b64_tr_b16 v[92:93], v17 offset:8192
  v_mfma_f32_16x16x32_bf16 v[28:31], v[60:63], v[152:155], v[28:31]
  ds_read_b64_tr_b16 v[94:95], v17 offset:12288
  v_lshlrev_b32 v4, 16, v156
  v_and_b32 v5, 0xffff0000, v156
  v_pk_add_f32 v[4:5], v[4:5], v[12:13] op_sel_hi:[1,0]
  v_cvt_pk_bf16_f32 v156, v4, v5
  v_mfma_f32_16x16x32_bf16 v[32:35], v[64:67], v[152:155], v[32:35]
  ds_read_b64_tr_b16 v[96:97], v18 offset:8192
  ds_read_b64_tr_b16 v[98:99], v18 offset:12288
  ds_read_b64_tr_b16 v[100:101], v19 offset:8192
  v_mfma_f32_16x16x32_bf16 v[36:39], v[68:71], v[152:155], v[36:39]
  ds_read_b64_tr_b16 v[102:103], v19 offset:12288
  v_lshlrev_b32 v6, 16, v157
  v_and_b32 v7, 0xffff0000, v157
  v_pk_add_f32 v[6:7], v[6:7], v[12:13] op_sel_hi:[1,0]
  v_cvt_pk_bf16_f32 v157, v6, v7
  v_mfma_f32_16x16x32_bf16 v[40:43], v[72:75], v[152:155], v[40:43]
  ds_read_b64_tr_b16 v[104:105], v20 offset:8192
  ds_read_b64_tr_b16 v[106:107], v20 offset:12288
  ds_read_b64_tr_b16 v[108:109], v21 offset:8192
  v_mfma_f32_16x16x32_bf16 v[44:47], v[76:79], v[152:155], v[44:47]
  ds_read_b64_tr_b16 v[110:111], v21 offset:12288
  v_lshlrev_b32 v8, 16, v158
  v_and_b32 v9, 0xffff0000, v158
  v_pk_add_f32 v[8:9], v[8:9], v[12:13] op_sel_hi:[1,0]
  v_cvt_pk_bf16_f32 v158, v8, v9
  v_mfma_f32_16x16x32_bf16 v[48:51], v[80:83], v[152:155], v[48:51]
  ds_read_b64_tr_b16 v[112:113], v22 offset:8192
  ds_read_b64_tr_b16 v[114:115], v22 offset:12288
  ds_read_b64_tr_b16 v[116:117], v23 offset:8192
  v_mfma_f32_16x16x32_bf16 v[52:55], v[84:87], v[152:155], v[52:55]
  ds_read_b64_tr_b16 v[118:119], v23 offset:12288
  v_lshlrev_b32 v4, 16, v159
  v_and_b32 v5, 0xffff0000, v159
  v_pk_add_f32 v[4:5], v[4:5], v[12:13] op_sel_hi:[1,0]
  v_cvt_pk_bf16_f32 v159, v4, v5
  s_waitcnt lgkmcnt(0)
  s_nop 1
  v_mfma_f32_16x16x32_bf16 v[24:27], v[88:91], v[156:159], v[24:27]
  ds_read_b64_tr_b16 v[56:57], v16 offset:16384
  ds_read_b64_tr_b16 v[58:59], v16 offset:20480
  ds_read_b64_tr_b16 v[60:61], v17 offset:16384
  v_mfma_f32_16x16x32_bf16 v[28:31], v[92:95], v[156:159], v[28:31]
  ds_read_b64_tr_b16 v[62:63], v17 offset:20480
  v_lshlrev_b32 v4, 16, v160
  v_and_b32 v5, 0xffff0000, v160
  v_pk_add_f32 v[4:5], v[4:5], v[12:13] op_sel_hi:[1,0]
  v_cvt_pk_bf16_f32 v160, v4, v5
  v_mfma_f32_16x16x32_bf16 v[32:35], v[96:99], v[156:159], v[32:35]
  ds_read_b64_tr_b16 v[64:65], v18 offset:16384
  ds_read_b64_tr_b16 v[66:67], v18 offset:20480
  ds_read_b64_tr_b16 v[68:69], v19 offset:16384
  v_mfma_f32_16x16x32_bf16 v[36:39], v[100:103], v[156:159], v[36:39]
  ds_read_b64_tr_b16 v[70:71], v19 offset:20480
  v_lshlrev_b32 v6, 16, v161
  v_and_b32 v7, 0xffff0000, v161
  v_pk_add_f32 v[6:7], v[6:7], v[12:13] op_sel_hi:[1,0]
  v_cvt_pk_bf16_f32 v161, v6, v7
  v_mfma_f32_16x16x32_bf16 v[40:43], v[104:107], v[156:159], v[40:43]
  ds_read_b64_tr_b16 v[72:73], v20 offset:16384
  ds_read_b64_tr_b16 v[74:75], v20 offset:20480
  ds_read_b64_tr_b16 v[76:77], v21 offset:16384
  v_mfma_f32_16x16x32_bf16 v[44:47], v[108:111], v[156:159], v[44:47]
  ds_read_b64_tr_b16 v[78:79], v21 offset:20480
  v_lshlrev_b32 v8, 16, v162
  v_and_b32 v9, 0xffff0000, v162
  v_pk_add_f32 v[8:9], v[8:9], v[12:13] op_sel_hi:[1,0]
  v_cvt_pk_bf16_f32 v162, v8, v9
  v_mfma_f32_16x16x32_bf16 v[48:51], v[112:115], v[156:159], v[48:51]
  ds_read_b64_tr_b16 v[80:81], v22 offset:16384
  ds_read_b64_tr_b16 v[82:83], v22 offset:20480
  ds_read_b64_tr_b16 v[84:85], v23 offset:16384
  v_mfma_f32_16x16x32_bf16 v[52:55], v[116:119], v[156:159], v[52:55]
  ds_read_b64_tr_b16 v[86:87], v23 offset:20480
  v_lshlrev_b32 v4, 16, v163
  v_and_b32 v5, 0xffff0000, v163
  v_pk_add_f32 v[4:5], v[4:5], v[12:13] op_sel_hi:[1,0]
  v_cvt_pk_bf16_f32 v163, v4, v5
  s_waitcnt lgkmcnt(0)
  s_nop 1
  v_mfma_f32_16x16x32_bf16 v[24:27], v[56:59], v[160:163], v[24:27]
  ds_read_b64_tr_b16 v[88:89], v16 offset:24576
  ds_read_b64_tr_b16 v[90:91], v16 offset:28672
  ds_read_b64_tr_b16 v[92:93], v17 offset:24576
  v_mfma_f32_16x16x32_bf16 v[28:31], v[60:63], v[160:163], v[28:31]
  ds_read_b64_tr_b16 v[94:95], v17 offset:28672
  v_lshlrev_b32 v4, 16, v164
  v_and_b32 v5, 0xffff0000, v164
  v_pk_add_f32 v[4:5], v[4:5], v[12:13] op_sel_hi:[1,0]
  v_cvt_pk_bf16_f32 v164, v4, v5
  v_mfma_f32_16x16x32_bf16 v[32:35], v[64:67], v[160:163], v[32:35]
  ds_read_b64_tr_b16 v[96:97], v18 offset:24576
  ds_read_b64_tr_b16 v[98:99], v18 offset:28672
  ds_read_b64_tr_b16 v[100:101], v19 offset:24576
  v_mfma_f32_16x16x32_bf16 v[36:39], v[68:71], v[160:163], v[36:39]
  ds_read_b64_tr_b16 v[102:103], v19 offset:28672
  v_lshlrev_b32 v6, 16, v165
  v_and_b32 v7, 0xffff0000, v165
  v_pk_add_f32 v[6:7], v[6:7], v[12:13] op_sel_hi:[1,0]
  v_cvt_pk_bf16_f32 v165, v6, v7
  v_mfma_f32_16x16x32_bf16 v[40:43], v[72:75], v[160:163], v[40:43]
  ds_read_b64_tr_b16 v[104:105], v20 offset:24576
  ds_read_b64_tr_b16 v[106:107], v20 offset:28672
  ds_read_b64_tr_b16 v[108:109], v21 offset:24576
  v_mfma_f32_16x16x32_bf16 v[44:47], v[76:79], v[160:163], v[44:47]
  ds_read_b64_tr_b16 v[110:111], v21 offset:28672
  v_lshlrev_b32 v8, 16, v166
  v_and_b32 v9, 0xffff0000, v166
  v_pk_add_f32 v[8:9], v[8:9], v[12:13] op_sel_hi:[1,0]
  v_cvt_pk_bf16_f32 v166, v8, v9
  v_mfma_f32_16x16x32_bf16 v[48:51], v[80:83], v[160:163], v[48:51]
  ds_read_b64_tr_b16 v[112:113], v22 offset:24576
  ds_read_b64_tr_b16 v[114:115], v22 offset:28672
  ds_read_b64_tr_b16 v[116:117], v23 offset:24576
  v_mfma_f32_16x16x32_bf16 v[52:55], v[84:87], v[160:163], v[52:55]
  ds_read_b64_tr_b16 v[118:119], v23 offset:28672
  v_lshlrev_b32 v4, 16, v167
  v_and_b32 v5, 0xffff0000, v167
  v_pk_add_f32 v[4:5], v[4:5], v[12:13] op_sel_hi:[1,0]
  v_cvt_pk_bf16_f32 v167, v4, v5
  s_waitcnt vmcnt(0)
  s_barrier
  s_waitcnt lgkmcnt(0)
  s_nop 1
  v_mfma_f32_16x16x32_bf16 v[24:27], v[88:91], v[164:167], v[24:27]
  ds_read_b64_tr_b16 v[56:57], v16 offset:32768
  ds_read_b64_tr_b16 v[58:59], v16 offset:36864
  ds_read_b64_tr_b16 v[60:61], v17 offset:32768
  v_mfma_f32_16x16x32_bf16 v[28:31], v[92:95], v[164:167], v[28:31]
  ds_read_b64_tr_b16 v[62:63], v17 offset:36864
  v_lshlrev_b32 v4, 16, v120
  v_and_b32 v5, 0xffff0000, v120
  v_pk_add_f32 v[4:5], v[4:5], v[12:13] op_sel_hi:[1,0]
  v_cvt_pk_bf16_f32 v120, v4, v5
  v_mfma_f32_16x16x32_bf16 v[32:35], v[96:99], v[164:167], v[32:35]
  ds_read_b64_tr_b16 v[64:65], v18 offset:32768
  ds_read_b64_tr_b16 v[66:67], v18 offset:36864
  ds_read_b64_tr_b16 v[68:69], v19 offset:32768
  v_mfma_f32_16x16x32_bf16 v[36:39], v[100:103], v[164:167], v[36:39]
  ds_read_b64_tr_b16 v[70:71], v19 offset:36864
  v_lshlrev_b32 v6, 16, v121
  v_and_b32 v7, 0xffff0000, v121
  v_pk_add_f32 v[6:7], v[6:7], v[12:13] op_sel_hi:[1,0]
  v_cvt_pk_bf16_f32 v121, v6, v7
  v_mfma_f32_16x16x32_bf16 v[40:43], v[104:107], v[164:167], v[40:43]
  ds_read_b64_tr_b16 v[72:73], v20 offset:32768
  ds_read_b64_tr_b16 v[74:75], v20 offset:36864
  ds_read_b64_tr_b16 v[76:77], v21 offset:32768
  v_mfma_f32_16x16x32_bf16 v[44:47], v[108:111], v[164:167], v[44:47]
  ds_read_b64_tr_b16 v[78:79], v21 offset:36864
  v_lshlrev_b32 v8, 16, v122
  v_and_b32 v9, 0xffff0000, v122
  v_pk_add_f32 v[8:9], v[8:9], v[12:13] op_sel_hi:[1,0]
  v_cvt_pk_bf16_f32 v122, v8, v9
  v_mfma_f32_16x16x32_bf16 v[48:51], v[112:115], v[164:167], v[48:51]
  ds_read_b64_tr_b16 v[80:81], v22 offset:32768
  ds_read_b64_tr_b16 v[82:83], v22 offset:36864
  ds_read_b64_tr_b16 v[84:85], v23 offset:32768
  v_mfma_f32_16x16x32_bf16 v[52:55], v[116:119], v[164:167], v[52:55]
  ds_read_b64_tr_b16 v[86:87], v23 offset:36864
  v_lshlrev_b32 v4, 16, v123
  v_and_b32 v5, 0xffff0000, v123
  v_pk_add_f32 v[4:5], v[4:5], v[12:13] op_sel_hi:[1,0]
  v_cvt_pk_bf16_f32 v123, v4, v5
  s_waitcnt lgkmcnt(0)
  s_nop 1
  v_mfma_f32_16x16x32_bf16 v[24:27], v[56:59], v[120:123], v[24:27]
  ds_read_b64_tr_b16 v[88:89], v16 offset:40960
  ds_read_b64_tr_b16 v[90:91], v16 offset:45056
  ds_read_b64_tr_b16 v[92:93], v17 offset:40960
  v_mfma_f32_16x16x32_bf16 v[28:31], v[60:63], v[120:123], v[28:31]
  ds_read_b64_tr_b16 v[94:95], v17 offset:45056
  v_lshlrev_b32 v4, 16, v124
  v_and_b32 v5, 0xffff0000, v124
  v_pk_add_f32 v[4:5], v[4:5], v[12:13] op_sel_hi:[1,0]
  v_cvt_pk_bf16_f32 v124, v4, v5
  v_mfma_f32_16x16x32_bf16 v[32:35], v[64:67], v[120:123], v[32:35]
  ds_read_b64_tr_b16 v[96:97], v18 offset:40960
  ds_read_b64_tr_b16 v[98:99], v18 offset:45056
  ds_read_b64_tr_b16 v[100:101], v19 offset:40960
  v_mfma_f32_16x16x32_bf16 v[36:39], v[68:71], v[120:123], v[36:39]
  ds_read_b64_tr_b16 v[102:103], v19 offset:45056
  v_lshlrev_b32 v6, 16, v125
  v_and_b32 v7, 0xffff0000, v125
  v_pk_add_f32 v[6:7], v[6:7], v[12:13] op_sel_hi:[1,0]
  v_cvt_pk_bf16_f32 v125, v6, v7
  v_mfma_f32_16x16x32_bf16 v[40:43], v[72:75], v[120:123], v[40:43]
  ds_read_b64_tr_b16 v[104:105], v20 offset:40960
  ds_read_b64_tr_b16 v[106:107], v20 offset:45056
  ds_read_b64_tr_b16 v[108:109], v21 offset:40960
  v_mfma_f32_16x16x32_bf16 v[44:47], v[76:79], v[120:123], v[44:47]
  ds_read_b64_tr_b16 v[110:111], v21 offset:45056
  v_lshlrev_b32 v8, 16, v126
  v_and_b32 v9, 0xffff0000, v126
  v_pk_add_f32 v[8:9], v[8:9], v[12:13] op_sel_hi:[1,0]
  v_cvt_pk_bf16_f32 v126, v8, v9
  v_mfma_f32_16x16x32_bf16 v[48:51], v[80:83], v[120:123], v[48:51]
  ds_read_b64_tr_b16 v[112:113], v22 offset:40960
  ds_read_b64_tr_b16 v[114:115], v22 offset:45056
  ds_read_b64_tr_b16 v[116:117], v23 offset:40960
  v_mfma_f32_16x16x32_bf16 v[52:55], v[84:87], v[120:123], v[52:55]
  ds_read_b64_tr_b16 v[118:119], v23 offset:45056
  v_lshlrev_b32 v4, 16, v127
  v_and_b32 v5, 0xffff0000, v127
  v_pk_add_f32 v[4:5], v[4:5], v[12:13] op_sel_hi:[1,0]
  v_cvt_pk_bf16_f32 v127, v4, v5
  s_waitcnt lgkmcnt(0)
  s_nop 1
  v_mfma_f32_16x16x32_bf16 v[24:27], v[88:91], v[124:127], v[24:27]
  ds_read_b64_tr_b16 v[56:57], v16 offset:49152
  ds_read_b64_tr_b16 v[58:59], v16 offset:53248
  ds_read_b64_tr_b16 v[60:61], v17 offset:49152
  v_mfma_f32_16x16x32_bf16 v[28:31], v[92:95], v[124:127], v[28:31]
  ds_read_b64_tr_b16 v[62:63], v17 offset:53248
  v_lshlrev_b32 v4, 16, v128
  v_and_b32 v5, 0xffff0000, v128
  v_pk_add_f32 v[4:5], v[4:5], v[12:13] op_sel_hi:[1,0]
  v_cvt_pk_bf16_f32 v128, v4, v5
  v_mfma_f32_16x16x32_bf16 v[32:35], v[96:99], v[124:127], v[32:35]
  ds_read_b64_tr_b16 v[64:65], v18 offset:49152
  ds_read_b64_tr_b16 v[66:67], v18 offset:53248
  ds_read_b64_tr_b16 v[68:69], v19 offset:49152
  v_mfma_f32_16x16x32_bf16 v[36:39], v[100:103], v[124:127], v[36:39]
  ds_read_b64_tr_b16 v[70:71], v19 offset:53248
  v_lshlrev_b32 v6, 16, v129
  v_and_b32 v7, 0xffff0000, v129
  v_pk_add_f32 v[6:7], v[6:7], v[12:13] op_sel_hi:[1,0]
  v_cvt_pk_bf16_f32 v129, v6, v7
  v_mfma_f32_16x16x32_bf16 v[40:43], v[104:107], v[124:127], v[40:43]
  ds_read_b64_tr_b16 v[72:73], v20 offset:49152
  ds_read_b64_tr_b16 v[74:75], v20 offset:53248
  ds_read_b64_tr_b16 v[76:77], v21 offset:49152
  v_mfma_f32_16x16x32_bf16 v[44:47], v[108:111], v[124:127], v[44:47]
  ds_read_b64_tr_b16 v[78:79], v21 offset:53248
  v_lshlrev_b32 v8, 16, v130
  v_and_b32 v9, 0xffff0000, v130
  v_pk_add_f32 v[8:9], v[8:9], v[12:13] op_sel_hi:[1,0]
  v_cvt_pk_bf16_f32 v130, v8, v9
  v_mfma_f32_16x16x32_bf16 v[48:51], v[112:115], v[124:127], v[48:51]
  ds_read_b64_tr_b16 v[80:81], v22 offset:49152
  ds_read_b64_tr_b16 v[82:83], v22 offset:53248
  ds_read_b64_tr_b16 v[84:85], v23 offset:49152
  v_mfma_f32_16x16x32_bf16 v[52:55], v[116:119], v[124:127], v[52:55]
  ds_read_b64_tr_b16 v[86:87], v23 offset:53248
  v_lshlrev_b32 v4, 16, v131
  v_and_b32 v5, 0xffff0000, v131
  v_pk_add_f32 v[4:5], v[4:5], v[12:13] op_sel_hi:[1,0]
  v_cvt_pk_bf16_f32 v131, v4, v5
  s_waitcnt lgkmcnt(0)
  s_nop 1
  v_mfma_f32_16x16x32_bf16 v[24:27], v[56:59], v[128:131], v[24:27]
  ds_read_b64_tr_b16 v[88:89], v16 offset:57344
  ds_read_b64_tr_b16 v[90:91], v16 offset:61440
  ds_read_b64_tr_b16 v[92:93], v17 offset:57344
  v_mfma_f32_16x16x32_bf16 v[28:31], v[60:63], v[128:131], v[28:31]
  ds_read_b64_tr_b16 v[94:95], v17 offset:61440
  v_lshlrev_b32 v4, 16, v132
  v_and_b32 v5, 0xffff0000, v132
  v_pk_add_f32 v[4:5], v[4:5], v[12:13] op_sel_hi:[1,0]
  v_cvt_pk_bf16_f32 v132, v4, v5
  v_mfma_f32_16x16x32_bf16 v[32:35], v[64:67], v[128:131], v[32:35]
  ds_read_b64_tr_b16 v[96:97], v18 offset:57344
  ds_read_b64_tr_b16 v[98:99], v18 offset:61440
  ds_read_b64_tr_b16 v[100:101], v19 offset:57344
  v_mfma_f32_16x16x32_bf16 v[36:39], v[68:71], v[128:131], v[36:39]
  ds_read_b64_tr_b16 v[102:103], v19 offset:61440
  v_lshlrev_b32 v6, 16, v133
  v_and_b32 v7, 0xffff0000, v133
  v_pk_add_f32 v[6:7], v[6:7], v[12:13] op_sel_hi:[1,0]
  v_cvt_pk_bf16_f32 v133, v6, v7
  v_mfma_f32_16x16x32_bf16 v[40:43], v[72:75], v[128:131], v[40:43]
  ds_read_b64_tr_b16 v[104:105], v20 offset:57344
  ds_read_b64_tr_b16 v[106:107], v20 offset:61440
  ds_read_b64_tr_b16 v[108:109], v21 offset:57344
  v_mfma_f32_16x16x32_bf16 v[44:47], v[76:79], v[128:131], v[44:47]
  ds_read_b64_tr_b16 v[110:111], v21 offset:61440
  v_lshlrev_b32 v8, 16, v134
  v_and_b32 v9, 0xffff0000, v134
  v_pk_add_f32 v[8:9], v[8:9], v[12:13] op_sel_hi:[1,0]
  v_cvt_pk_bf16_f32 v134, v8, v9
  v_mfma_f32_16x16x32_bf16 v[48:51], v[80:83], v[128:131], v[48:51]
  ds_read_b64_tr_b16 v[112:113], v22 offset:57344
  ds_read_b64_tr_b16 v[114:115], v22 offset:61440
  ds_read_b64_tr_b16 v[116:117], v23 offset:57344
  v_mfma_f32_16x16x32_bf16 v[52:55], v[84:87], v[128:131], v[52:55]
  ds_read_b64_tr_b16 v[118:119], v23 offset:61440
  v_lshlrev_b32 v4, 16, v135
  v_and_b32 v5, 0xffff0000, v135
  v_pk_add_f32 v[4:5], v[4:5], v[12:13] op_sel_hi:[1,0]
  v_cvt_pk_bf16_f32 v135, v4, v5
  s_waitcnt lgkmcnt(0)
  s_nop 1
  v_mfma_f32_16x16x32_bf16 v[24:27], v[88:91], v[132:135], v[24:27]
  v_mfma_f32_16x16x32_bf16 v[28:31], v[92:95], v[132:135], v[28:31]
  v_mfma_f32_16x16x32_bf16 v[32:35], v[96:99], v[132:135], v[32:35]
  v_mfma_f32_16x16x32_bf16 v[36:39], v[100:103], v[132:135], v[36:39]
  v_mfma_f32_16x16x32_bf16 v[40:43], v[104:107], v[132:135], v[40:43]
  v_mfma_f32_16x16x32_bf16 v[44:47], v[108:111], v[132:135], v[44:47]
  v_mfma_f32_16x16x32_bf16 v[48:51], v[112:115], v[132:135], v[48:51]
  v_mfma_f32_16x16x32_bf16 v[52:55], v[116:119], v[132:135], v[52:55]
  s_nop 7
  s_nop 1
  v_mul_f32 v4, 0xbfb8aa3b, v13
  v_mul_f32 v120, v4, v24
  v_exp_f32 v120, v120
  v_mul_f32 v121, v4, v25
  v_exp_f32 v121, v121
  v_mul_f32 v122, v4, v26
  v_exp_f32 v122, v122
  v_mul_f32 v123, v4, v27
  v_exp_f32 v123, v123
  v_mul_f32 v24, v13, v24
  v_mul_f32 v25, v13, v25
  v_mul_f32 v26, v13, v26
  v_mul_f32 v27, v13, v27
  v_add_f32 v120, 1.0, v120
  v_rcp_f32 v120, v120
  v_add_f32 v121, 1.0, v121
  v_rcp_f32 v121, v121
  v_add_f32 v122, 1.0, v122
  v_rcp_f32 v122, v122
  v_add_f32 v123, 1.0, v123
  v_rcp_f32 v123, v123
  s_nop 0
  v_mul_f32 v24, v24, v120
  v_mul_f32 v25, v25, v121
  v_mul_f32 v26, v26, v122
  v_mul_f32 v27, v27, v123
  v_cvt_pk_bf16_f32 v56, v24, v25
  v_cvt_pk_bf16_f32 v57, v26, v27
  v_mul_f32 v120, v4, v28
  v_exp_f32 v120, v120
  v_mul_f32 v121, v4, v29
  v_exp_f32 v121, v121
  v_mul_f32 v122, v4, v30
  v_exp_f32 v122, v122
  v_mul_f32 v123, v4, v31
  v_exp_f32 v123, v123
  v_mul_f32 v28, v13, v28
  v_mul_f32 v29, v13, v29
  v_mul_f32 v30, v13, v30
  v_mul_f32 v31, v13, v31
  v_add_f32 v120, 1.0, v120
  v_rcp_f32 v120, v120
  v_add_f32 v121, 1.0, v121
  v_rcp_f32 v121, v121
  v_add_f32 v122, 1.0, v122
  v_rcp_f32 v122, v122
  v_add_f32 v123, 1.0, v123
  v_rcp_f32 v123, v123
  s_nop 0
  v_mul_f32 v28, v28, v120
  v_mul_f32 v29, v29, v121
  v_mul_f32 v30, v30, v122
  v_mul_f32 v31, v31, v123
  v_cvt_pk_bf16_f32 v58, v28, v29
  v_cvt_pk_bf16_f32 v59, v30, v31
  v_mul_f32 v120, v4, v32
  v_exp_f32 v120, v120
  v_mul_f32 v121, v4, v33
  v_exp_f32 v121, v121
  v_mul_f32 v122, v4, v34
  v_exp_f32 v122, v122
  v_mul_f32 v123, v4, v35
  v_exp_f32 v123, v123
  v_mul_f32 v32, v13, v32
  v_mul_f32 v33, v13, v33
  v_mul_f32 v34, v13, v34
  v_mul_f32 v35, v13, v35
  v_add_f32 v120, 1.0, v120
  v_rcp_f32 v120, v120
  v_add_f32 v121, 1.0, v121
  v_rcp_f32 v121, v121
  v_add_f32 v122, 1.0, v122
  v_rcp_f32 v122, v122
  v_add_f32 v123, 1.0, v123
  v_rcp_f32 v123, v123
  s_nop 0
  v_mul_f32 v32, v32, v120
  v_mul_f32 v33, v33, v121
  v_mul_f32 v34, v34, v122
  v_mul_f32 v35, v35, v123
  v_cvt_pk_bf16_f32 v60, v32, v33
  v_cvt_pk_bf16_f32 v61, v34, v35
  v_mul_f32 v120, v4, v36
  v_exp_f32 v120, v120
  v_mul_f32 v121, v4, v37
  v_exp_f32 v121, v121
  v_mul_f32 v122, v4, v38
  v_exp_f32 v122, v122
  v_mul_f32 v123, v4, v39
  v_exp_f32 v123, v123
  v_mul_f32 v36, v13, v36
  v_mul_f32 v37, v13, v37
  v_mul_f32 v38, v13, v38
  v_mul_f32 v39, v13, v39
  v_add_f32 v120, 1.0, v120
  v_rcp_f32 v120, v120
  v_add_f32 v121, 1.0, v121
  v_rcp_f32 v121, v121
  v_add_f32 v122, 1.0, v122
  v_rcp_f32 v122, v122
  v_add_f32 v123, 1.0, v123
  v_rcp_f32 v123, v123
  s_nop 0
  v_mul_f32 v36, v36, v120
  v_mul_f32 v37, v37, v121
  v_mul_f32 v38, v38, v122
  v_mul_f32 v39, v39, v123
  v_cvt_pk_bf16_f32 v62, v36, v37
  v_cvt_pk_bf16_f32 v63, v38, v39
  v_mul_f32 v120, v4, v40
  v_exp_f32 v120, v120
  v_mul_f32 v121, v4, v41
  v_exp_f32 v121, v121
  v_mul_f32 v122, v4, v42
  v_exp_f32 v122, v122
  v_mul_f32 v123, v4, v43
  v_exp_f32 v123, v123
  v_mul_f32 v40, v13, v40
  v_mul_f32 v41, v13, v41
  v_mul_f32 v42, v13, v42
  v_mul_f32 v43, v13, v43
  v_add_f32 v120, 1.0, v120
  v_rcp_f32 v120, v120
  v_add_f32 v121, 1.0, v121
  v_rcp_f32 v121, v121
  v_add_f32 v122, 1.0, v122
  v_rcp_f32 v122, v122
  v_add_f32 v123, 1.0, v123
  v_rcp_f32 v123, v123
  s_nop 0
  v_mul_f32 v40, v40, v120
  v_mul_f32 v41, v41, v121
  v_mul_f32 v42, v42, v122
  v_mul_f32 v43, v43, v123
  v_cvt_pk_bf16_f32 v64, v40, v41
  v_cvt_pk_bf16_f32 v65, v42, v43
  v_mul_f32 v120, v4, v44
  v_exp_f32 v120, v120
  v_mul_f32 v121, v4, v45
  v_exp_f32 v121, v121
  v_mul_f32 v122, v4, v46
  v_exp_f32 v122, v122
  v_mul_f32 v123, v4, v47
  v_exp_f32 v123, v123
  v_mul_f32 v44, v13, v44
  v_mul_f32 v45, v13, v45
  v_mul_f32 v46, v13, v46
  v_mul_f32 v47, v13, v47
  v_add_f32 v120, 1.0, v120
  v_rcp_f32 v120, v120
  v_add_f32 v121, 1.0, v121
  v_rcp_f32 v121, v121
  v_add_f32 v122, 1.0, v122
  v_rcp_f32 v122, v122
  v_add_f32 v123, 1.0, v123
  v_rcp_f32 v123, v123
  s_nop 0
  v_mul_f32 v44, v44, v120
  v_mul_f32 v45, v45, v121
  v_mul_f32 v46, v46, v122
  v_mul_f32 v47, v47, v123
  v_cvt_pk_bf16_f32 v66, v44, v45
  v_cvt_pk_bf16_f32 v67, v46, v47
  v_mul_f32 v120, v4, v48
  v_exp_f32 v120, v120
  v_mul_f32 v121, v4, v49
  v_exp_f32 v121, v121
  v_mul_f32 v122, v4, v50
  v_exp_f32 v122, v122
  v_mul_f32 v123, v4, v51
  v_exp_f32 v123, v123
  v_mul_f32 v48, v13, v48
  v_mul_f32 v49, v13, v49
  v_mul_f32 v50, v13, v50
  v_mul_f32 v51, v13, v51
  v_add_f32 v120, 1.0, v120
  v_rcp_f32 v120, v120
  v_add_f32 v121, 1.0, v121
  v_rcp_f32 v121, v121
  v_add_f32 v122, 1.0, v122
  v_rcp_f32 v122, v122
  v_add_f32 v123, 1.0, v123
  v_rcp_f32 v123, v123
  s_nop 0
  v_mul_f32 v48, v48, v120
  v_mul_f32 v49, v49, v121
  v_mul_f32 v50, v50, v122
  v_mul_f32 v51, v51, v123
  v_cvt_pk_bf16_f32 v68, v48, v49
  v_cvt_pk_bf16_f32 v69, v50, v51
  v_mul_f32 v120, v4, v52
  v_exp_f32 v120, v120
  v_mul_f32 v121, v4, v53
  v_exp_f32 v121, v121
  v_mul_f32 v122, v4, v54
  v_exp_f32 v122, v122
  v_mul_f32 v123, v4, v55
  v_exp_f32 v123, v123
  v_mul_f32 v52, v13, v52
  v_mul_f32 v53, v13, v53
  v_mul_f32 v54, v13, v54
  v_mul_f32 v55, v13, v55
  v_add_f32 v120, 1.0, v120
  v_rcp_f32 v120, v120
  v_add_f32 v121, 1.0, v121
  v_rcp_f32 v121, v121
  v_add_f32 v122, 1.0, v122
  v_rcp_f32 v122, v122
  v_add_f32 v123, 1.0, v123
  v_rcp_f32 v123, v123
  s_nop 0
  v_mul_f32 v52, v52, v120
  v_mul_f32 v53, v53, v121
  v_mul_f32 v54, v54, v122
  v_mul_f32 v55, v55, v123
  v_cvt_pk_bf16_f32 v70, v52, v53
  v_cvt_pk_bf16_f32 v71, v54, v55
  v_lshlrev_b32 v6, 4, v1
  s_lshl_b32 s6, s3, 3
  s_add_u32 s6, s6, s5
  s_mul_i32 s6, s6, 56
  s_lshl_b32 s7, s4, 2
  s_add_u32 s6, s6, s7
  s_lshl_b32 s6, s6, 10
  s_add_u32 s6, s6, 8388608
  buffer_store_dwordx4 v[56:59], v6, s[12:15], s6 offen offset:0
  buffer_store_dwordx4 v[60:63], v6, s[12:15], s6 offen offset:1024
  buffer_store_dwordx4 v[64:67], v6, s[12:15], s6 offen offset:2048
  buffer_store_dwordx4 v[68:71], v6, s[12:15], s6 offen offset:3072
  s_cmp_ge_u32 s5, 4
  s_cbranch_scc1 k3_kernel_end
k3_kernel_end:
  s_endpgm
.globl k4_kernel
.p2align 8
.type k4_kernel,@function
k4_kernel:
  s_cmp_ge_u32 s2, 256
  s_cbranch_scc1 k4_kernel_end
  s_load_dwordx2 s[38:39], s[0:1], 40
  s_load_dwordx2 s[40:41], s[0:1], 48
  s_load_dwordx2 s[42:43], s[0:1], 64
  s_and_b32 s6, s2, 7
  s_lshr_b32 s7, s6, 1
  s_lshl_b32 s3, s7, 3
  s_bfe_u32 s7, s2, 0x30003
  s_add_u32 s3, s3, s7
  s_and_b32 s7, s6, 1
  s_lshl_b32 s4, s7, 2
  s_lshr_b32 s7, s2, 6
  s_add_u32 s4, s4, s7
  v_and_b32 v1, 63, v0
  v_lshrrev_b32 v4, 6, v0
  v_lshrrev_b32 v2, 4, v1
  v_readfirstlane_b32 s5, v4
  v_and_b32 v3, 15, v1
  s_waitcnt lgkmcnt(0)
  s_lshl_b32 s6, s4, 7
  s_add_u32 s8, s38, s6
  s_addc_u32 s9, s39, 0
  s_sub_u32 s10, 1835008, s6
  s_mov_b32 s11, 0x00020000
  s_mov_b32 s12, s42
  s_mov_b32 s13, s43
  s_mov_b32 s14, 268435456
  s_mov_b32 s15, 0x00020000
  s_mov_b32 s16, s40
  s_mov_b32 s17, s41
  s_mov_b32 s18, 2097152
  s_mov_b32 s19, 0x00020000
  v_lshrrev_b32 v4, 3, v1
  v_lshlrev_b32 v12, 10, v4
  v_bfe_u32 v4, v1, 1, 2
  v_bfe_u32 v5, v1, 4, 2
  v_xor_b32 v4, v4, v5
  v_and_b32 v5, 1, v1
  v_lshl_or_b32 v4, v4, 1, v5
  v_lshl_add_u32 v12, v4, 4, v12
  v_lshlrev_b32 v13, 4, v1
  s_lshl_b32 s6, s3, 2
  s_add_u32 s6, s6, s5
  s_mul_i32 s46, s6, 57344
  s_add_u32 s46, s46, 8388608
  s_lshl_b32 s47, s6, 14
  s_lshl_b32 s7, s4, 11
  s_add_u32 s47, s47, s7
  s_add_u32 s47, s47, 4194304
  s_lshl_b32 s44, s5, 10
  s_lshl_b32 s45, s5, 13
  buffer_load_dwordx4 v[20:23], v13, s[12:15], s47 offen offset:0
  buffer_load_dwordx4 v[24:27], v13, s[12:15], s47 offen offset:1024
  s_add_u32 m0, s44, 0
  s_add_u32 s7, s45, 0
  buffer_load_dwordx4 v12, s[8:11], s7 offen lds
  s_add_u32 s48, s46, 0
  buffer_load_dwordx4 v[76:79], v13, s[12:15], s48 offen
  s_add_u32 m0, s44, 4096
  s_add_u32 s7, s45, 32768
  buffer_load_dwordx4 v12, s[8:11], s7 offen lds
  s_add_u32 s48, s46, 1024
  buffer_load_dwordx4 v[80:83], v13, s[12:15], s48 offen
  s_add_u32 m0, s44, 8192
  s_add_u32 s7, s45, 65536
  buffer_load_dwordx4 v12, s[8:11], s7 offen lds
  s_add_u32 s48, s46, 2048
  buffer_load_dwordx4 v[84:87], v13, s[12:15], s48 offen
  s_add_u32 m0, s44, 12288
  s_add_u32 s7, s45, 98304
  buffer_load_dwordx4 v12, s[8:11], s7 offen lds
  s_add_u32 s48, s46, 3072
  buffer_load_dwordx4 v[88:91], v13, s[12:15], s48 offen
  s_add_u32 m0, s44, 16384
  s_add_u32 s7, s45, 131072
  buffer_load_dwordx4 v12, s[8:11], s7 offen lds
  s_add_u32 s48, s46, 4096
  buffer_load_dwordx4 v[92:95], v13, s[12:15], s48 offen
  s_add_u32 m0, s44, 20480
  s_add_u32 s7, s45, 163840
  buffer_load_dwordx4 v12, s[8:11], s7 offen lds
  s_add_u32 s48, s46, 5120
  buffer_load_dwordx4 v[96:99], v13, s[12:15], s48 offen
  s_add_u32 m0, s44, 24576
  s_add_u32 s7, s45, 196608
  buffer_load_dwordx4 v12, s[8:11], s7 offen lds
  s_add_u32 s48, s46, 6144
  buffer_load_dwordx4 v[100:103], v13, s[12:15], s48 offen
  s_add_u32 m0, s44, 28672
  s_add_u32 s7, s45, 229376
  buffer_load_dwordx4 v12, s[8:11], s7 offen lds
  s_add_u32 s48, s46, 7168
  buffer_load_dwordx4 v[104:107], v13, s[12:15], s48 offen
  s_add_u32 m0, s44, 32768
  s_add_u32 s7, s45, 262144
  buffer_load_dwordx4 v12, s[8:11], s7 offen lds
  s_add_u32 s48, s46, 8192
  buffer_load_dwordx4 v[108:111], v13, s[12:15], s48 offen
  s_add_u32 m0, s44, 36864
  s_add_u32 s7, s45, 294912
  buffer_load_dwordx4 v12, s[8:11], s7 offen lds
  s_add_u32 s48, s46, 9216
  buffer_load_dwordx4 v[112:115], v13, s[12:15], s48 offen
  s_add_u32 m0, s44, 40960
  s_add_u32 s7, s45, 327680
  buffer_load_dwordx4 v12, s[8:11], s7 offen lds
  s_add_u32 s48, s46, 10240
  buffer_load_dwordx4 v[116:119], v13, s[12:15], s48 offen
  s_add_u32 m0, s44, 45056
  s_add_u32 s7, s45, 360448
  buffer_load_dwordx4 v12, s[8:11], s7 offen lds
  s_add_u32 s48, s46, 11264
  buffer_load_dwordx4 v[120:123], v13, s[12:15], s48 offen
  v_bfe_u32 v4, v1, 2, 2
  v_lshl_add_u32 v5, v2, 2, v4
  v_lshlrev_b32 v5, 7, v5
  v_and_b32 v6, 3, v1
  v_lshl_add_u32 v5, v6, 3, v5
  v_lshrrev_b32 v4, 1, v4
  v_lshl_add_u32 v4, v2, 1, v4
  v_and_b32 v4, 3, v4
  v_xor_b32 v6, 0, v4
  v_lshl_add_u32 v16, v6, 5, v5
  v_xor_b32 v6, 1, v4
  v_lshl_add_u32 v17, v6, 5, v5
  v_xor_b32 v6, 2, v4
  v_lshl_add_u32 v18, v6, 5, v5
  v_xor_b32 v6, 3, v4
  v_lshl_add_u32 v19, v6, 5, v5
  s_waitcnt vmcnt(16)
  s_barrier
  ds_read_b64_tr_b16 v[44:45], v16 offset:0
  ds_read_b64_tr_b16 v[46:47], v16 offset:2048
  ds_read_b64_tr_b16 v[48:49], v17 offset:0
  ds_read_b64_tr_b16 v[50:51], v17 offset:2048
  ds_read_b64_tr_b16 v[52:53], v18 offset:0
  ds_read_b64_tr_b16 v[54:55], v18 offset:2048
  ds_read_b64_tr_b16 v[56:57], v19 offset:0
  ds_read_b64_tr_b16 v[58:59], v19 offset:2048
  s_waitcnt lgkmcnt(0)
  v_mfma_f32_16x16x32_bf16 v[28:31], v[44:47], v[76:79], 0
  ds_read_b64_tr_b16 v[60:61], v16 offset:4096
  ds_read_b64_tr_b16 v[62:63], v16 offset:6144
  v_mfma_f32_16x16x32_bf16 v[32:35], v[48:51], v[76:79], 0
  ds_read_b64_tr_b16 v[64:65], v17 offset:4096
  ds_read_b64_tr_b16 v[66:67], v17 offset:6144
  v_mfma_f32_16x16x32_bf16 v[36:39], v[52:55], v[76:79], 0
  ds_read_b64_tr_b16 v[68:69], v18 offset:4096
  ds_read_b64_tr_b16 v[70:71], v18 offset:6144
  v_mfma_f32_16x16x32_bf16 v[40:43], v[56:59], v[76:79], 0
  ds_read_b64_tr_b16 v[72:73], v19 offset:4096
  ds_read_b64_tr_b16 v[74:75], v19 offset:6144
  s_waitcnt lgkmcnt(0)
  v_mfma_f32_16x16x32_bf16 v[28:31], v[60:63], v[80:83], v[28:31]
  ds_read_b64_tr_b16 v[44:45], v16 offset:8192
  ds_read_b64_tr_b16 v[46:47], v16 offset:10240
  v_mfma_f32_16x16x32_bf16 v[32:35], v[64:67], v[80:83], v[32:35]
  ds_read_b64_tr_b16 v[48:49], v17 offset:8192
  ds_read_b64_tr_b16 v[50:51], v17 offset:10240
  v_mfma_f32_16x16x32_bf16 v[36:39], v[68:71], v[80:83], v[36:39]
  ds_read_b64_tr_b16 v[52:53], v18 offset:8192
  ds_read_b64_tr_b16 v[54:55], v18 offset:10240
  v_mfma_f32_16x16x32_bf16 v[40:43], v[72:75], v[80:83], v[40:43]
  ds_read_b64_tr_b16 v[56:57], v19 offset:8192
  ds_read_b64_tr_b16 v[58:59], v19 offset:10240
  s_waitcnt lgkmcnt(0)
  v_mfma_f32_16x16x32_bf16 v[28:31], v[44:47], v[84:87], v[28:31]
  ds_read_b64_tr_b16 v[60:61], v16 offset:12288
  ds_read_b64_tr_b16 v[62:63], v16 offset:14336
  v_mfma_f32_16x16x32_bf16 v[32:35], v[48:51], v[84:87], v[32:35]
  ds_read_b64_tr_b16 v[64:65], v17 offset:12288
  ds_read_b64_tr_b16 v[66:67], v17 offset:14336
  v_mfma_f32_16x16x32_bf16 v[36:39], v[52:55], v[84:87], v[36:39]
  ds_read_b64_tr_b16 v[68:69], v18 offset:12288
  ds_read_b64_tr_b16 v[70:71], v18 offset:14336
  v_mfma_f32_16x16x32_bf16 v[40:43], v[56:59], v[84:87], v[40:43]
  ds_read_b64_tr_b16 v[72:73], v19 offset:12288
  ds_read_b64_tr_b16 v[74:75], v19 offset:14336
  s_waitcnt vmcnt(8)
  s_barrier
  s_waitcnt lgkmcnt(0)
  v_mfma_f32_16x16x32_bf16 v[28:31], v[60:63], v[88:91], v[28:31]
  ds_read_b64_tr_b16 v[44:45], v16 offset:16384
  ds_read_b64_tr_b16 v[46:47], v16 offset:18432
  ds_read_b64_tr_b16 v[48:49], v17 offset:16384
  v_mfma_f32_16x16x32_bf16 v[32:35], v[64:67], v[88:91], v[32:35]
  s_add_u32 m0, s44, 49152
  s_add_u32 s7, s45, 393216
  buffer_load_dwordx4 v12, s[8:11], s7 offen lds
  ds_read_b64_tr_b16 v[50:51], v17 offset:18432
  ds_read_b64_tr_b16 v[52:53], v18 offset:16384
  v_mfma_f32_16x16x32_bf16 v[36:39], v[68:71], v[88:91], v[36:39]
  ds_read_b64_tr_b16 v[54:55], v18 offset:18432
  s_add_u32 s48, s46, 12288
  buffer_load_dwordx4 v[124:127], v13, s[12:15], s48 offen
  ds_read_b64_tr_b16 v[56:57], v19 offset:16384
  v_mfma_f32_16x16x32_bf16 v[40:43], v[72:75], v[88:91], v[40:43]
  ds_read_b64_tr_b16 v[58:59], v19 offset:18432
  s_add_u32 m0, s44, 53248
  s_add_u32 s7, s45, 425984
  buffer_load_dwordx4 v12, s[8:11], s7 offen lds
  s_waitcnt lgkmcnt(0)
  v_mfma_f32_16x16x32_bf16 v[28:31], v[44:47], v[92:95], v[28:31]
  ds_read_b64_tr_b16 v[60:61], v16 offset:20480
  ds_read_b64_tr_b16 v[62:63], v16 offset:22528
  ds_read_b64_tr_b16 v[64:65], v17 offset:20480
  v_mfma_f32_16x16x32_bf16 v[32:35], v[48:51], v[92:95], v[32:35]
  s_add_u32 s48, s46, 13312
  buffer_load_dwordx4 v[128:131], v13, s[12:15], s48 offen
  ds_read_b64_tr_b16 v[66:67], v17 offset:22528
  ds_read_b64_tr_b16 v[68:69], v18 offset:20480
  v_mfma_f32_16x16x32_bf16 v[36:39], v[52:55], v[92:95], v[36:39]
  ds_read_b64_tr_b16 v[70:71], v18 offset:22528
  s_add_u32 m0, s44, 57344
  s_add_u32 s7, s45, 458752
  buffer_load_dwordx4 v12, s[8:11], s7 offen lds
  ds_read_b64_tr_b16 v[72:73], v19 offset:20480
  v_mfma_f32_16x16x32_bf16 v[40:43], v[56:59], v[92:95], v[40:43]
  ds_read_b64_tr_b16 v[74:75], v19 offset:22528
  s_add_u32 s48, s46, 14336
  buffer_load_dwordx4 v[132:135], v13, s[12:15], s48 offen
  s_waitcnt lgkmcnt(0)
  v_mfma_f32_16x16x32_bf16 v[28:31], v[60:63], v[96:99], v[28:31]
  ds_read_b64_tr_b16 v[44:45], v16 offset:24576
  ds_read_b64_tr_b16 v[46:47], v16 offset:26624
  ds_read_b64_tr_b16 v[48:49], v17 offset:24576
  v_mfma_f32_16x16x32_bf16 v[32:35], v[64:67], v[96:99], v[32:35]
  s_add_u32 m0, s44, 61440
  s_add_u32 s7, s45, 491520
  buffer_load_dwordx4 v12, s[8:11], s7 offen lds
  ds_read_b64_tr_b16 v[50:51], v17 offset:26624
  v_mfma_f32_16x16x32_bf16 v[36:39], v[68:71], v[96:99], v[36:39]
  ds_read_b64_tr_b16 v[52:53], v18 offset:24576
  ds_read_b64_tr_b16 v[54:55], v18 offset:26624
  s_add_u32 s48, s46, 15360
  buffer_load_dwordx4 v[136:139], v13, s[12:15], s48 offen
  v_mfma_f32_16x16x32_bf16 v[40:43], v[72:75], v[96:99], v[40:43]
  ds_read_b64_tr_b16 v[56:57], v19 offset:24576
  ds_read_b64_tr_b16 v[58:59], v19 offset:26624
  s_waitcnt lgkmcnt(0)
  v_mfma_f32_16x16x32_bf16 v[28:31], v[44:47], v[100:103], v[28:31]
  ds_read_b64_tr_b16 v[60:61], v16 offset:28672
  ds_read_b64_tr_b16 v[62:63], v16 offset:30720
  v_mfma_f32_16x16x32_bf16 v[32:35], v[48:51], v[100:103], v[32:35]
  ds_read_b64_tr_b16 v[64:65], v17 offset:28672
  ds_read_b64_tr_b16 v[66:67], v17 offset:30720
  v_mfma_f32_16x16x32_bf16 v[36:39], v[52:55], v[100:103], v[36:39]
  ds_read_b64_tr_b16 v[68:69], v18 offset:28672
  ds_read_b64_tr_b16 v[70:71], v18 offset:30720
  v_mfma_f32_16x16x32_bf16 v[40:43], v[56:59], v[100:103], v[40:43]
  ds_read_b64_tr_b16 v[72:73], v19 offset:28672
  ds_read_b64_tr_b16 v[74:75], v19 offset:30720
  s_waitcnt vmcnt(8)
  s_barrier
  s_waitcnt lgkmcnt(0)
  v_mfma_f32_16x16x32_bf16 v[28:31], v[60:63], v[104:107], v[28:31]
  ds_read_b64_tr_b16 v[44:45], v16 offset:32768
  ds_read_b64_tr_b16 v[46:47], v16 offset:34816
  ds_read_b64_tr_b16 v[48:49], v17 offset:32768
  v_mfma_f32_16x16x32_bf16 v[32:35], v[64:67], v[104:107], v[32:35]
  s_add_u32 m0, s44, 0
  s_add_u32 s7, s45, 524288
  buffer_load_dwordx4 v12, s[8:11], s7 offen lds
  ds_read_b64_tr_b16 v[50:51], v17 offset:34816
  ds_read_b64_tr_b16 v[52:53], v18 offset:32768
  v_mfma_f32_16x16x32_bf16 v[36:39], v[68:71], v[104:107], v[36:39]
  ds_read_b64_tr_b16 v[54:55], v18 offset:34816
  s_add_u32 s48, s46, 16384
  buffer_load_dwordx4 v[76:79], v13, s[12:15], s48 offen
  ds_read_b64_tr_b16 v[56:57], v19 offset:32768
  v_mfma_f32_16x16x32_bf16 v[40:43], v[72:75], v[104:107], v[40:43]
  ds_read_b64_tr_b16 v[58:59], v19 offset:34816
  s_add_u32 m0, s44, 4096
  s_add_u32 s7, s45, 557056
  buffer_load_dwordx4 v12, s[8:11], s7 offen lds
  s_waitcnt lgkmcnt(0)
  v_mfma_f32_16x16x32_bf16 v[28:31], v[44:47], v[108:111], v[28:31]
  ds_read_b64_tr_b16 v[60:61], v16 offset:36864
  ds_read_b64_tr_b16 v[62:63], v16 offset:38912
  ds_read_b64_tr_b16 v[64:65], v17 offset:36864
  v_mfma_f32_16x16x32_bf16 v[32:35], v[48:51], v[108:111], v[32:35]
  s_add_u32 s48, s46, 17408
  buffer_load_dwordx4 v[80:83], v13, s[12:15], s48 offen
  ds_read_b64_tr_b16 v[66:67], v17 offset:38912
  ds_read_b64_tr_b16 v[68:69], v18 offset:36864
  v_mfma_f32_16x16x32_bf16 v[36:39], v[52:55], v[108:111], v[36:39]
  ds_read_b64_tr_b16 v[70:71], v18 offset:38912
  s_add_u32 m0, s44, 8192
  s_add_u32 s7, s45, 589824
  buffer_load_dwordx4 v12, s[8:11], s7 offen lds
  ds_read_b64_tr_b16 v[72:73], v19 offset:36864
  v_mfma_f32_16x16x32_bf16 v[40:43], v[56:59], v[108:111], v[40:43]
  ds_read_b64_tr_b16 v[74:75], v19 offset:38912
  s_add_u32 s48, s46, 18432
  buffer_load_dwordx4 v[84:87], v13, s[12:15], s48 offen
  s_waitcnt lgkmcnt(0)
  v_mfma_f32_16x16x32_bf16 v[28:31], v[60:63], v[112:115], v[28:31]
  ds_read_b64_tr_b16 v[44:45], v16 offset:40960
  ds_read_b64_tr_b16 v[46:47], v16 offset:43008
  ds_read_b64_tr_b16 v[48:49], v17 offset:40960
  v_mfma_f32_16x16x32_bf16 v[32:35], v[64:67], v[112:115], v[32:35]
  s_add_u32 m0, s44, 12288
  s_add_u32 s7, s45, 622592
  buffer_load_dwordx4 v12, s[8:11], s7 offen lds
  ds_read_b64_tr_b16 v[50:51], v17 offset:43008
  v_mfma_f32_16x16x32_bf16 v[36:39], v[68:71], v[112:115], v[36:39]
  ds_read_b64_tr_b16 v[52:53], v18 offset:40960
  ds_read_b64_tr_b16 v[54:55], v18 offset:43008
  s_add_u32 s48, s46, 19456
  buffer_load_dwordx4 v[88:91], v13, s[12:15], s48 offen
  v_mfma_f32_16x16x32_bf16 v[40:43], v[72:75], v[112:115], v[40:43]
  ds_read_b64_tr_b16 v[56:57], v19 offset:40960
  ds_read_b64_tr_b16 v[58:59], v19 offset:43008
  s_waitcnt lgkmcnt(0)
  v_mfma_f32_16x16x32_bf16 v[28:31], v[44:47], v[116:119], v[28:31]
  ds_read_b64_tr_b16 v[60:61], v16 offset:45056
  ds_read_b64_tr_b16 v[62:63], v16 offset:47104
  v_mfma_f32_16x16x32_bf16 v[32:35], v[48:51], v[116:119], v[32:35]
  ds_read_b64_tr_b16 v[64:65], v17 offset:45056
  ds_read_b64_tr_b16 v[66:67], v17 offset:47104
  v_mfma_f32_16x16x32_bf16 v[36:39], v[52:55], v[116:119], v[36:39]
  ds_read_b64_tr_b16 v[68:69], v18 offset:45056
  ds_read_b64_tr_b16 v[70:71], v18 offset:47104
  v_mfma_f32_16x16x32_bf16 v[40:43], v[56:59], v[116:119], v[40:43]
  ds_read_b64_tr_b16 v[72:73], v19 offset:45056
  ds_read_b64_tr_b16 v[74:75], v19 offset:47104
  s_waitcnt vmcnt(8)
  s_barrier
  s_waitcnt lgkmcnt(0)
  v_mfma_f32_16x16x32_bf16 v[28:31], v[60:63], v[120:123], v[28:31]
  ds_read_b64_tr_b16 v[44:45], v16 offset:49152
  ds_read_b64_tr_b16 v[46:47], v16 offset:51200
  ds_read_b64_tr_b16 v[48:49], v17 offset:49152
  v_mfma_f32_16x16x32_bf16 v[32:35], v[64:67], v[120:123], v[32:35]
  s_add_u32 m0, s44, 16384
  s_add_u32 s7, s45, 655360
  buffer_load_dwordx4 v12, s[8:11], s7 offen lds
  ds_read_b64_tr_b16 v[50:51], v17 offset:51200
  ds_read_b64_tr_b16 v[52:53], v18 offset:49152
  v_mfma_f32_16x16x32_bf16 v[36:39], v[68:71], v[120:123], v[36:39]
  ds_read_b64_tr_b16 v[54:55], v18 offset:51200
  s_add_u32 s48, s46, 20480
  buffer_load_dwordx4 v[92:95], v13, s[12:15], s48 offen
  ds_read_b64_tr_b16 v[56:57], v19 offset:49152
  v_mfma_f32_16x16x32_bf16 v[40:43], v[72:75], v[120:123], v[40:43]
  ds_read_b64_tr_b16 v[58:59], v19 offset:51200
  s_add_u32 m0, s44, 20480
  s_add_u32 s7, s45, 688128
  buffer_load_dwordx4 v12, s[8:11], s7 offen lds
  s_waitcnt lgkmcnt(0)
  v_mfma_f32_16x16x32_bf16 v[28:31], v[44:47], v[124:127], v[28:31]
  ds_read_b64_tr_b16 v[60:61], v16 offset:53248
  ds_read_b64_tr_b16 v[62:63], v16 offset:55296
  ds_read_b64_tr_b16 v[64:65], v17 offset:53248
  v_mfma_f32_16x16x32_bf16 v[32:35], v[48:51], v[124:127], v[32:35]
  s_add_u32 s48, s46, 21504
  buffer_load_dwordx4 v[96:99], v13, s[12:15], s48 offen
  ds_read_b64_tr_b16 v[66:67], v17 offset:55296
  ds_read_b64_tr_b16 v[68:69], v18 offset:53248
  v_mfma_f32_16x16x32_bf16 v[36:39], v[52:55], v[124:127], v[36:39]
  ds_read_b64_tr_b16 v[70:71], v18 offset:55296
  s_add_u32 m0, s44, 24576
  s_add_u32 s7, s45, 720896
  buffer_load_dwordx4 v12, s[8:11], s7 offen lds
  ds_read_b64_tr_b16 v[72:73], v19 offset:53248
  v_mfma_f32_16x16x32_bf16 v[40:43], v[56:59], v[124:127], v[40:43]
  ds_read_b64_tr_b16 v[74:75], v19 offset:55296
  s_add_u32 s48, s46, 22528
  buffer_load_dwordx4 v[100:103], v13, s[12:15], s48 offen
  s_waitcnt lgkmcnt(0)
  v_mfma_f32_16x16x32_bf16 v[28:31], v[60:63], v[128:131], v[28:31]
  ds_read_b64_tr_b16 v[44:45], v16 offset:57344
  ds_read_b64_tr_b16 v[46:47], v16 offset:59392
  ds_read_b64_tr_b16 v[48:49], v17 offset:57344
  v_mfma_f32_16x16x32_bf16 v[32:35], v[64:67], v[128:131], v[32:35]
  s_add_u32 m0, s44, 28672
  s_add_u32 s7, s45, 753664
  buffer_load_dwordx4 v12, s[8:11], s7 offen lds
  ds_read_b64_tr_b16 v[50:51], v17 offset:59392
  v_mfma_f32_16x16x32_bf16 v[36:39], v[68:71], v[128:131], v[36:39]
  ds_read_b64_tr_b16 v[52:53], v18 offset:57344
  ds_read_b64_tr_b16 v[54:55], v18 offset:59392
  s_add_u32 s48, s46, 23552
  buffer_load_dwordx4 v[104:107], v13, s[12:15], s48 offen
  v_mfma_f32_16x16x32_bf16 v[40:43], v[72:75], v[128:131], v[40:43]
  ds_read_b64_tr_b16 v[56:57], v19 offset:57344
  ds_read_b64_tr_b16 v[58:59], v19 offset:59392
  s_waitcnt lgkmcnt(0)
  v_mfma_f32_16x16x32_bf16 v[28:31], v[44:47], v[132:135], v[28:31]
  ds_read_b64_tr_b16 v[60:61], v16 offset:61440
  ds_read_b64_tr_b16 v[62:63], v16 offset:63488
  v_mfma_f32_16x16x32_bf16 v[32:35], v[48:51], v[132:135], v[32:35]
  ds_read_b64_tr_b16 v[64:65], v17 offset:61440
  ds_read_b64_tr_b16 v[66:67], v17 offset:63488
  v_mfma_f32_16x16x32_bf16 v[36:39], v[52:55], v[132:135], v[36:39]
  ds_read_b64_tr_b16 v[68:69], v18 offset:61440
  ds_read_b64_tr_b16 v[70:71], v18 offset:63488
  v_mfma_f32_16x16x32_bf16 v[40:43], v[56:59], v[132:135], v[40:43]
  ds_read_b64_tr_b16 v[72:73], v19 offset:61440
  ds_read_b64_tr_b16 v[74:75], v19 offset:63488
  s_waitcnt vmcnt(8)
  s_barrier
  s_waitcnt lgkmcnt(0)
  v_mfma_f32_16x16x32_bf16 v[28:31], v[60:63], v[136:139], v[28:31]
  ds_read_b64_tr_b16 v[44:45], v16 offset:0
  ds_read_b64_tr_b16 v[46:47], v16 offset:2048
  ds_read_b64_tr_b16 v[48:49], v17 offset:0
  v_mfma_f32_16x16x32_bf16 v[32:35], v[64:67], v[136:139], v[32:35]
  s_add_u32 m0, s44, 32768
  s_add_u32 s7, s45, 786432
  buffer_load_dwordx4 v12, s[8:11], s7 offen lds
  ds_read_b64_tr_b16 v[50:51], v17 offset:2048
  ds_read_b64_tr_b16 v[52:53], v18 offset:0
  v_mfma_f32_16x16x32_bf16 v[36:39], v[68:71], v[136:139], v[36:39]
  ds_read_b64_tr_b16 v[54:55], v18 offset:2048
  s_add_u32 s48, s46, 24576
  buffer_load_dwordx4 v[108:111], v13, s[12:15], s48 offen
  ds_read_b64_tr_b16 v[56:57], v19 offset:0
  v_mfma_f32_16x16x32_bf16 v[40:43], v[72:75], v[136:139], v[40:43]
  ds_read_b64_tr_b16 v[58:59], v19 offset:2048
  s_add_u32 m0, s44, 36864
  s_add_u32 s7, s45, 819200
  buffer_load_dwordx4 v12, s[8:11], s7 offen lds
  s_waitcnt lgkmcnt(0)
  v_mfma_f32_16x16x32_bf16 v[28:31], v[44:47], v[76:79], v[28:31]
  ds_read_b64_tr_b16 v[60:61], v16 offset:4096
  ds_read_b64_tr_b16 v[62:63], v16 offset:6144
  ds_read_b64_tr_b16 v[64:65], v17 offset:4096
  v_mfma_f32_16x16x32_bf16 v[32:35], v[48:51], v[76:79], v[32:35]
  s_add_u32 s48, s46, 25600
  buffer_load_dwordx4 v[112:115], v13, s[12:15], s48 offen
  ds_read_b64_tr_b16 v[66:67], v17 offset:6144
  ds_read_b64_tr_b16 v[68:69], v18 offset:4096
  v_mfma_f32_16x16x32_bf16 v[36:39], v[52:55], v[76:79], v[36:39]
  ds_read_b64_tr_b16 v[70:71], v18 offset:6144
  s_add_u32 m0, s44, 40960
  s_add_u32 s7, s45, 851968
  buffer_load_dwordx4 v12, s[8:11], s7 offen lds
  ds_read_b64_tr_b16 v[72:73], v19 offset:4096
  v_mfma_f32_16x16x32_bf16 v[40:43], v[56:59], v[76:79], v[40:43]
  ds_read_b64_tr_b16 v[74:75], v19 offset:6144
  s_add_u32 s48, s46, 26624
  buffer_load_dwordx4 v[116:119], v13, s[12:15], s48 offen
  s_waitcnt lgkmcnt(0)
  v_mfma_f32_16x16x32_bf16 v[28:31], v[60:63], v[80:83], v[28:31]
  ds_read_b64_tr_b16 v[44:45], v16 offset:8192
  ds_read_b64_tr_b16 v[46:47], v16 offset:10240
  ds_read_b64_tr_b16 v[48:49], v17 offset:8192
  v_mfma_f32_16x16x32_bf16 v[32:35], v[64:67], v[80:83], v[32:35]
  s_add_u32 m0, s44, 45056
  s_add_u32 s7, s45, 884736
  buffer_load_dwordx4 v12, s[8:11], s7 offen lds
  ds_read_b64_tr_b16 v[50:51], v17 offset:10240
  v_mfma_f32_16x16x32_bf16 v[36:39], v[68:71], v[80:83], v[36:39]
  ds_read_b64_tr_b16 v[52:53], v18 offset:8192
  ds_read_b64_tr_b16 v[54:55], v18 offset:10240
  s_add_u32 s48, s46, 27648
  buffer_load_dwordx4 v[120:123], v13, s[12:15], s48 offen
  v_mfma_f32_16x16x32_bf16 v[40:43], v[72:75], v[80:83], v[40:43]
  ds_read_b64_tr_b16 v[56:57], v19 offset:8192
  ds_read_b64_tr_b16 v[58:59], v19 offset:10240
  s_waitcnt lgkmcnt(0)
  v_mfma_f32_16x16x32_bf16 v[28:31], v[44:47], v[84:87], v[28:31]
  ds_read_b64_tr_b16 v[60:61], v16 offset:12288
  ds_read_b64_tr_b16 v[62:63], v16 offset:14336
  v_mfma_f32_16x16x32_bf16 v[32:35], v[48:51], v[84:87], v[32:35]
  ds_read_b64_tr_b16 v[64:65], v17 offset:12288
  ds_read_b64_tr_b16 v[66:67], v17 offset:14336
  v_mfma_f32_16x16x32_bf16 v[36:39], v[52:55], v[84:87], v[36:39]
  ds_read_b64_tr_b16 v[68:69], v18 offset:12288
  ds_read_b64_tr_b16 v[70:71], v18 offset:14336
  v_mfma_f32_16x16x32_bf16 v[40:43], v[56:59], v[84:87], v[40:43]
  ds_read_b64_tr_b16 v[72:73], v19 offset:12288
  ds_read_b64_tr_b16 v[74:75], v19 offset:14336
  s_waitcnt vmcnt(8)
  s_barrier
  s_waitcnt lgkmcnt(0)
  v_mfma_f32_16x16x32_bf16 v[28:31], v[60:63], v[88:91], v[28:31]
  ds_read_b64_tr_b16 v[44:45], v16 offset:16384
  ds_read_b64_tr_b16 v[46:47], v16 offset:18432
  ds_read_b64_tr_b16 v[48:49], v17 offset:16384
  v_mfma_f32_16x16x32_bf16 v[32:35], v[64:67], v[88:91], v[32:35]
  s_add_u32 m0, s44, 49152
  s_add_u32 s7, s45, 917504
  buffer_load_dwordx4 v12, s[8:11], s7 offen lds
  ds_read_b64_tr_b16 v[50:51], v17 offset:18432
  ds_read_b64_tr_b16 v[52:53], v18 offset:16384
  v_mfma_f32_16x16x32_bf16 v[36:39], v[68:71], v[88:91], v[36:39]
  ds_read_b64_tr_b16 v[54:55], v18 offset:18432
  s_add_u32 s48, s46, 28672
  buffer_load_dwordx4 v[124:127], v13, s[12:15], s48 offen
  ds_read_b64_tr_b16 v[56:57], v19 offset:16384
  v_mfma_f32_16x16x32_bf16 v[40:43], v[72:75], v[88:91], v[40:43]
  ds_read_b64_tr_b16 v[58:59], v19 offset:18432
  s_add_u32 m0, s44, 53248
  s_add_u32 s7, s45, 950272
  buffer_load_dwordx4 v12, s[8:11], s7 offen lds
  s_waitcnt lgkmcnt(0)
  v_mfma_f32_16x16x32_bf16 v[28:31], v[44:47], v[92:95], v[28:31]
  ds_read_b64_tr_b16 v[60:61], v16 offset:20480
  ds_read_b64_tr_b16 v[62:63], v16 offset:22528
  ds_read_b64_tr_b16 v[64:65], v17 offset:20480
  v_mfma_f32_16x16x32_bf16 v[32:35], v[48:51], v[92:95], v[32:35]
  s_add_u32 s48, s46, 29696
  buffer_load_dwordx4 v[128:131], v13, s[12:15], s48 offen
  ds_read_b64_tr_b16 v[66:67], v17 offset:22528
  ds_read_b64_tr_b16 v[68:69], v18 offset:20480
  v_mfma_f32_16x16x32_bf16 v[36:39], v[52:55], v[92:95], v[36:39]
  ds_read_b64_tr_b16 v[70:71], v18 offset:22528
  s_add_u32 m0, s44, 57344
  s_add_u32 s7, s45, 983040
  buffer_load_dwordx4 v12, s[8:11], s7 offen lds
  ds_read_b64_tr_b16 v[72:73], v19 offset:20480
  v_mfma_f32_16x16x32_bf16 v[40:43], v[56:59], v[92:95], v[40:43]
  ds_read_b64_tr_b16 v[74:75], v19 offset:22528
  s_add_u32 s48, s46, 30720
  buffer_load_dwordx4 v[132:135], v13, s[12:15], s48 offen
  s_waitcnt lgkmcnt(0)
  v_mfma_f32_16x16x32_bf16 v[28:31], v[60:63], v[96:99], v[28:31]
  ds_read_b64_tr_b16 v[44:45], v16 offset:24576
  ds_read_b64_tr_b16 v[46:47], v16 offset:26624
  ds_read_b64_tr_b16 v[48:49], v17 offset:24576
  v_mfma_f32_16x16x32_bf16 v[32:35], v[64:67], v[96:99], v[32:35]
  s_add_u32 m0, s44, 61440
  s_add_u32 s7, s45, 1015808
  buffer_load_dwordx4 v12, s[8:11], s7 offen lds
  ds_read_b64_tr_b16 v[50:51], v17 offset:26624
  v_mfma_f32_16x16x32_bf16 v[36:39], v[68:71], v[96:99], v[36:39]
  ds_read_b64_tr_b16 v[52:53], v18 offset:24576
  ds_read_b64_tr_b16 v[54:55], v18 offset:26624
  s_add_u32 s48, s46, 31744
  buffer_load_dwordx4 v[136:139], v13, s[12:15], s48 offen
  v_mfma_f32_16x16x32_bf16 v[40:43], v[72:75], v[96:99], v[40:43]
  ds_read_b64_tr_b16 v[56:57], v19 offset:24576
  ds_read_b64_tr_b16 v[58:59], v19 offset:26624
  s_waitcnt lgkmcnt(0)
  v_mfma_f32_16x16x32_bf16 v[28:31], v[44:47], v[100:103], v[28:31]
  ds_read_b64_tr_b16 v[60:61], v16 offset:28672
  ds_read_b64_tr_b16 v[62:63], v16 offset:30720
  v_mfma_f32_16x16x32_bf16 v[32:35], v[48:51], v[100:103], v[32:35]
  ds_read_b64_tr_b16 v[64:65], v17 offset:28672
  ds_read_b64_tr_b16 v[66:67], v17 offset:30720
  v_mfma_f32_16x16x32_bf16 v[36:39], v[52:55], v[100:103], v[36:39]
  ds_read_b64_tr_b16 v[68:69], v18 offset:28672
  ds_read_b64_tr_b16 v[70:71], v18 offset:30720
  v_mfma_f32_16x16x32_bf16 v[40:43], v[56:59], v[100:103], v[40:43]
  ds_read_b64_tr_b16 v[72:73], v19 offset:28672
  ds_read_b64_tr_b16 v[74:75], v19 offset:30720
  s_waitcnt vmcnt(8)
  s_barrier
  s_waitcnt lgkmcnt(0)
  v_mfma_f32_16x16x32_bf16 v[28:31], v[60:63], v[104:107], v[28:31]
  ds_read_b64_tr_b16 v[44:45], v16 offset:32768
  ds_read_b64_tr_b16 v[46:47], v16 offset:34816
  ds_read_b64_tr_b16 v[48:49], v17 offset:32768
  v_mfma_f32_16x16x32_bf16 v[32:35], v[64:67], v[104:107], v[32:35]
  s_add_u32 m0, s44, 0
  s_add_u32 s7, s45, 1048576
  buffer_load_dwordx4 v12, s[8:11], s7 offen lds
  ds_read_b64_tr_b16 v[50:51], v17 offset:34816
  ds_read_b64_tr_b16 v[52:53], v18 offset:32768
  v_mfma_f32_16x16x32_bf16 v[36:39], v[68:71], v[104:107], v[36:39]
  ds_read_b64_tr_b16 v[54:55], v18 offset:34816
  s_add_u32 s48, s46, 32768
  buffer_load_dwordx4 v[76:79], v13, s[12:15], s48 offen
  ds_read_b64_tr_b16 v[56:57], v19 offset:32768
  v_mfma_f32_16x16x32_bf16 v[40:43], v[72:75], v[104:107], v[40:43]
  ds_read_b64_tr_b16 v[58:59], v19 offset:34816
  s_add_u32 m0, s44, 4096
  s_add_u32 s7, s45, 1081344
  buffer_load_dwordx4 v12, s[8:11], s7 offen lds
  s_waitcnt lgkmcnt(0)
  v_mfma_f32_16x16x32_bf16 v[28:31], v[44:47], v[108:111], v[28:31]
  ds_read_b64_tr_b16 v[60:61], v16 offset:36864
  ds_read_b64_tr_b16 v[62:63], v16 offset:38912
  ds_read_b64_tr_b16 v[64:65], v17 offset:36864
  v_mfma_f32_16x16x32_bf16 v[32:35], v[48:51], v[108:111], v[32:35]
  s_add_u32 s48, s46, 33792
  buffer_load_dwordx4 v[80:83], v13, s[12:15], s48 offen
  ds_read_b64_tr_b16 v[66:67], v17 offset:38912
  ds_read_b64_tr_b16 v[68:69], v18 offset:36864
  v_mfma_f32_16x16x32_bf16 v[36:39], v[52:55], v[108:111], v[36:39]
  ds_read_b64_tr_b16 v[70:71], v18 offset:38912
  s_add_u32 m0, s44, 8192
  s_add_u32 s7, s45, 1114112
  buffer_load_dwordx4 v12, s[8:11], s7 offen lds
  ds_read_b64_tr_b16 v[72:73], v19 offset:36864
  v_mfma_f32_16x16x32_bf16 v[40:43], v[56:59], v[108:111], v[40:43]
  ds_read_b64_tr_b16 v[74:75], v19 offset:38912
  s_add_u32 s48, s46, 34816
  buffer_load_dwordx4 v[84:87], v13, s[12:15], s48 offen
  s_waitcnt lgkmcnt(0)
  v_mfma_f32_16x16x32_bf16 v[28:31], v[60:63], v[112:115], v[28:31]
  ds_read_b64_tr_b16 v[44:45], v16 offset:40960
  ds_read_b64_tr_b16 v[46:47], v16 offset:43008
  ds_read_b64_tr_b16 v[48:49], v17 offset:40960
  v_mfma_f32_16x16x32_bf16 v[32:35], v[64:67], v[112:115], v[32:35]
  s_add_u32 m0, s44, 12288
  s_add_u32 s7, s45, 1146880
  buffer_load_dwordx4 v12, s[8:11], s7 offen lds
  ds_read_b64_tr_b16 v[50:51], v17 offset:43008
  v_mfma_f32_16x16x32_bf16 v[36:39], v[68:71], v[112:115], v[36:39]
  ds_read_b64_tr_b16 v[52:53], v18 offset:40960
  ds_read_b64_tr_b16 v[54:55], v18 offset:43008
  s_add_u32 s48, s46, 35840
  buffer_load_dwordx4 v[88:91], v13, s[12:15], s48 offen
  v_mfma_f32_16x16x32_bf16 v[40:43], v[72:75], v[112:115], v[40:43]
  ds_read_b64_tr_b16 v[56:57], v19 offset:40960
  ds_read_b64_tr_b16 v[58:59], v19 offset:43008
  s_waitcnt lgkmcnt(0)
  v_mfma_f32_16x16x32_bf16 v[28:31], v[44:47], v[116:119], v[28:31]
  ds_read_b64_tr_b16 v[60:61], v16 offset:45056
  ds_read_b64_tr_b16 v[62:63], v16 offset:47104
  v_mfma_f32_16x16x32_bf16 v[32:35], v[48:51], v[116:119], v[32:35]
  ds_read_b64_tr_b16 v[64:65], v17 offset:45056
  ds_read_b64_tr_b16 v[66:67], v17 offset:47104
  v_mfma_f32_16x16x32_bf16 v[36:39], v[52:55], v[116:119], v[36:39]
  ds_read_b64_tr_b16 v[68:69], v18 offset:45056
  ds_read_b64_tr_b16 v[70:71], v18 offset:47104
  v_mfma_f32_16x16x32_bf16 v[40:43], v[56:59], v[116:119], v[40:43]
  ds_read_b64_tr_b16 v[72:73], v19 offset:45056
  ds_read_b64_tr_b16 v[74:75], v19 offset:47104
  s_waitcnt vmcnt(8)
  s_barrier
  s_waitcnt lgkmcnt(0)
  v_mfma_f32_16x16x32_bf16 v[28:31], v[60:63], v[120:123], v[28:31]
  ds_read_b64_tr_b16 v[44:45], v16 offset:49152
  ds_read_b64_tr_b16 v[46:47], v16 offset:51200
  ds_read_b64_tr_b16 v[48:49], v17 offset:49152
  v_mfma_f32_16x16x32_bf16 v[32:35], v[64:67], v[120:123], v[32:35]
  s_add_u32 m0, s44, 16384
  s_add_u32 s7, s45, 1179648
  buffer_load_dwordx4 v12, s[8:11], s7 offen lds
  ds_read_b64_tr_b16 v[50:51], v17 offset:51200
  ds_read_b64_tr_b16 v[52:53], v18 offset:49152
  v_mfma_f32_16x16x32_bf16 v[36:39], v[68:71], v[120:123], v[36:39]
  ds_read_b64_tr_b16 v[54:55], v18 offset:51200
  s_add_u32 s48, s46, 36864
  buffer_load_dwordx4 v[92:95], v13, s[12:15], s48 offen
  ds_read_b64_tr_b16 v[56:57], v19 offset:49152
  v_mfma_f32_16x16x32_bf16 v[40:43], v[72:75], v[120:123], v[40:43]
  ds_read_b64_tr_b16 v[58:59], v19 offset:51200
  s_add_u32 m0, s44, 20480
  s_add_u32 s7, s45, 1212416
  buffer_load_dwordx4 v12, s[8:11], s7 offen lds
  s_waitcnt lgkmcnt(0)
  v_mfma_f32_16x16x32_bf16 v[28:31], v[44:47], v[124:127], v[28:31]
  ds_read_b64_tr_b16 v[60:61], v16 offset:53248
  ds_read_b64_tr_b16 v[62:63], v16 offset:55296
  ds_read_b64_tr_b16 v[64:65], v17 offset:53248
  v_mfma_f32_16x16x32_bf16 v[32:35], v[48:51], v[124:127], v[32:35]
  s_add_u32 s48, s46, 37888
  buffer_load_dwordx4 v[96:99], v13, s[12:15], s48 offen
  ds_read_b64_tr_b16 v[66:67], v17 offset:55296
  ds_read_b64_tr_b16 v[68:69], v18 offset:53248
  v_mfma_f32_16x16x32_bf16 v[36:39], v[52:55], v[124:127], v[36:39]
  ds_read_b64_tr_b16 v[70:71], v18 offset:55296
  s_add_u32 m0, s44, 24576
  s_add_u32 s7, s45, 1245184
  buffer_load_dwordx4 v12, s[8:11], s7 offen lds
  ds_read_b64_tr_b16 v[72:73], v19 offset:53248
  v_mfma_f32_16x16x32_bf16 v[40:43], v[56:59], v[124:127], v[40:43]
  ds_read_b64_tr_b16 v[74:75], v19 offset:55296
  s_add_u32 s48, s46, 38912
  buffer_load_dwordx4 v[100:103], v13, s[12:15], s48 offen
  s_waitcnt lgkmcnt(0)
  v_mfma_f32_16x16x32_bf16 v[28:31], v[60:63], v[128:131], v[28:31]
  ds_read_b64_tr_b16 v[44:45], v16 offset:57344
  ds_read_b64_tr_b16 v[46:47], v16 offset:59392
  ds_read_b64_tr_b16 v[48:49], v17 offset:57344
  v_mfma_f32_16x16x32_bf16 v[32:35], v[64:67], v[128:131], v[32:35]
  s_add_u32 m0, s44, 28672
  s_add_u32 s7, s45, 1277952
  buffer_load_dwordx4 v12, s[8:11], s7 offen lds
  ds_read_b64_tr_b16 v[50:51], v17 offset:59392
  v_mfma_f32_16x16x32_bf16 v[36:39], v[68:71], v[128:131], v[36:39]
  ds_read_b64_tr_b16 v[52:53], v18 offset:57344
  ds_read_b64_tr_b16 v[54:55], v18 offset:59392
  s_add_u32 s48, s46, 39936
  buffer_load_dwordx4 v[104:107], v13, s[12:15], s48 offen
  v_mfma_f32_16x16x32_bf16 v[40:43], v[72:75], v[128:131], v[40:43]
  ds_read_b64_tr_b16 v[56:57], v19 offset:57344
  ds_read_b64_tr_b16 v[58:59], v19 offset:59392
  s_waitcnt lgkmcnt(0)
  v_mfma_f32_16x16x32_bf16 v[28:31], v[44:47], v[132:135], v[28:31]
  ds_read_b64_tr_b16 v[60:61], v16 offset:61440
  ds_read_b64_tr_b16 v[62:63], v16 offset:63488
  v_mfma_f32_16x16x32_bf16 v[32:35], v[48:51], v[132:135], v[32:35]
  ds_read_b64_tr_b16 v[64:65], v17 offset:61440
  ds_read_b64_tr_b16 v[66:67], v17 offset:63488
  v_mfma_f32_16x16x32_bf16 v[36:39], v[52:55], v[132:135], v[36:39]
  ds_read_b64_tr_b16 v[68:69], v18 offset:61440
  ds_read_b64_tr_b16 v[70:71], v18 offset:63488
  v_mfma_f32_16x16x32_bf16 v[40:43], v[56:59], v[132:135], v[40:43]
  ds_read_b64_tr_b16 v[72:73], v19 offset:61440
  ds_read_b64_tr_b16 v[74:75], v19 offset:63488
  s_waitcnt vmcnt(8)
  s_barrier
  s_waitcnt lgkmcnt(0)
  v_mfma_f32_16x16x32_bf16 v[28:31], v[60:63], v[136:139], v[28:31]
  ds_read_b64_tr_b16 v[44:45], v16 offset:0
  ds_read_b64_tr_b16 v[46:47], v16 offset:2048
  ds_read_b64_tr_b16 v[48:49], v17 offset:0
  v_mfma_f32_16x16x32_bf16 v[32:35], v[64:67], v[136:139], v[32:35]
  s_add_u32 m0, s44, 32768
  s_add_u32 s7, s45, 1310720
  buffer_load_dwordx4 v12, s[8:11], s7 offen lds
  ds_read_b64_tr_b16 v[50:51], v17 offset:2048
  ds_read_b64_tr_b16 v[52:53], v18 offset:0
  v_mfma_f32_16x16x32_bf16 v[36:39], v[68:71], v[136:139], v[36:39]
  ds_read_b64_tr_b16 v[54:55], v18 offset:2048
  s_add_u32 s48, s46, 40960
  buffer_load_dwordx4 v[108:111], v13, s[12:15], s48 offen
  ds_read_b64_tr_b16 v[56:57], v19 offset:0
  v_mfma_f32_16x16x32_bf16 v[40:43], v[72:75], v[136:139], v[40:43]
  ds_read_b64_tr_b16 v[58:59], v19 offset:2048
  s_add_u32 m0, s44, 36864
  s_add_u32 s7, s45, 1343488
  buffer_load_dwordx4 v12, s[8:11], s7 offen lds
  s_waitcnt lgkmcnt(0)
  v_mfma_f32_16x16x32_bf16 v[28:31], v[44:47], v[76:79], v[28:31]
  ds_read_b64_tr_b16 v[60:61], v16 offset:4096
  ds_read_b64_tr_b16 v[62:63], v16 offset:6144
  ds_read_b64_tr_b16 v[64:65], v17 offset:4096
  v_mfma_f32_16x16x32_bf16 v[32:35], v[48:51], v[76:79], v[32:35]
  s_add_u32 s48, s46, 41984
  buffer_load_dwordx4 v[112:115], v13, s[12:15], s48 offen
  ds_read_b64_tr_b16 v[66:67], v17 offset:6144
  ds_read_b64_tr_b16 v[68:69], v18 offset:4096
  v_mfma_f32_16x16x32_bf16 v[36:39], v[52:55], v[76:79], v[36:39]
  ds_read_b64_tr_b16 v[70:71], v18 offset:6144
  s_add_u32 m0, s44, 40960
  s_add_u32 s7, s45, 1376256
  buffer_load_dwordx4 v12, s[8:11], s7 offen lds
  ds_read_b64_tr_b16 v[72:73], v19 offset:4096
  v_mfma_f32_16x16x32_bf16 v[40:43], v[56:59], v[76:79], v[40:43]
  ds_read_b64_tr_b16 v[74:75], v19 offset:6144
  s_add_u32 s48, s46, 43008
  buffer_load_dwordx4 v[116:119], v13, s[12:15], s48 offen
  s_waitcnt lgkmcnt(0)
  v_mfma_f32_16x16x32_bf16 v[28:31], v[60:63], v[80:83], v[28:31]
  ds_read_b64_tr_b16 v[44:45], v16 offset:8192
  ds_read_b64_tr_b16 v[46:47], v16 offset:10240
  ds_read_b64_tr_b16 v[48:49], v17 offset:8192
  v_mfma_f32_16x16x32_bf16 v[32:35], v[64:67], v[80:83], v[32:35]
  s_add_u32 m0, s44, 45056
  s_add_u32 s7, s45, 1409024
  buffer_load_dwordx4 v12, s[8:11], s7 offen lds
  ds_read_b64_tr_b16 v[50:51], v17 offset:10240
  v_mfma_f32_16x16x32_bf16 v[36:39], v[68:71], v[80:83], v[36:39]
  ds_read_b64_tr_b16 v[52:53], v18 offset:8192
  ds_read_b64_tr_b16 v[54:55], v18 offset:10240
  s_add_u32 s48, s46, 44032
  buffer_load_dwordx4 v[120:123], v13, s[12:15], s48 offen
  v_mfma_f32_16x16x32_bf16 v[40:43], v[72:75], v[80:83], v[40:43]
  ds_read_b64_tr_b16 v[56:57], v19 offset:8192
  ds_read_b64_tr_b16 v[58:59], v19 offset:10240
  s_waitcnt lgkmcnt(0)
  v_mfma_f32_16x16x32_bf16 v[28:31], v[44:47], v[84:87], v[28:31]
  ds_read_b64_tr_b16 v[60:61], v16 offset:12288
  ds_read_b64_tr_b16 v[62:63], v16 offset:14336
  v_mfma_f32_16x16x32_bf16 v[32:35], v[48:51], v[84:87], v[32:35]
  ds_read_b64_tr_b16 v[64:65], v17 offset:12288
  ds_read_b64_tr_b16 v[66:67], v17 offset:14336
  v_mfma_f32_16x16x32_bf16 v[36:39], v[52:55], v[84:87], v[36:39]
  ds_read_b64_tr_b16 v[68:69], v18 offset:12288
  ds_read_b64_tr_b16 v[70:71], v18 offset:14336
  v_mfma_f32_16x16x32_bf16 v[40:43], v[56:59], v[84:87], v[40:43]
  ds_read_b64_tr_b16 v[72:73], v19 offset:12288
  ds_read_b64_tr_b16 v[74:75], v19 offset:14336
  s_waitcnt vmcnt(8)
  s_barrier
  s_waitcnt lgkmcnt(0)
  v_mfma_f32_16x16x32_bf16 v[28:31], v[60:63], v[88:91], v[28:31]
  ds_read_b64_tr_b16 v[44:45], v16 offset:16384
  ds_read_b64_tr_b16 v[46:47], v16 offset:18432
  ds_read_b64_tr_b16 v[48:49], v17 offset:16384
  v_mfma_f32_16x16x32_bf16 v[32:35], v[64:67], v[88:91], v[32:35]
  s_add_u32 m0, s44, 49152
  s_add_u32 s7, s45, 1441792
  buffer_load_dwordx4 v12, s[8:11], s7 offen lds
  ds_read_b64_tr_b16 v[50:51], v17 offset:18432
  ds_read_b64_tr_b16 v[52:53], v18 offset:16384
  v_mfma_f32_16x16x32_bf16 v[36:39], v[68:71], v[88:91], v[36:39]
  ds_read_b64_tr_b16 v[54:55], v18 offset:18432
  s_add_u32 s48, s46, 45056
  buffer_load_dwordx4 v[124:127], v13, s[12:15], s48 offen
  ds_read_b64_tr_b16 v[56:57], v19 offset:16384
  v_mfma_f32_16x16x32_bf16 v[40:43], v[72:75], v[88:91], v[40:43]
  ds_read_b64_tr_b16 v[58:59], v19 offset:18432
  s_add_u32 m0, s44, 53248
  s_add_u32 s7, s45, 1474560
  buffer_load_dwordx4 v12, s[8:11], s7 offen lds
  s_waitcnt lgkmcnt(0)
  v_mfma_f32_16x16x32_bf16 v[28:31], v[44:47], v[92:95], v[28:31]
  ds_read_b64_tr_b16 v[60:61], v16 offset:20480
  ds_read_b64_tr_b16 v[62:63], v16 offset:22528
  ds_read_b64_tr_b16 v[64:65], v17 offset:20480
  v_mfma_f32_16x16x32_bf16 v[32:35], v[48:51], v[92:95], v[32:35]
  s_add_u32 s48, s46, 46080
  buffer_load_dwordx4 v[128:131], v13, s[12:15], s48 offen
  ds_read_b64_tr_b16 v[66:67], v17 offset:22528
  ds_read_b64_tr_b16 v[68:69], v18 offset:20480
  v_mfma_f32_16x16x32_bf16 v[36:39], v[52:55], v[92:95], v[36:39]
  ds_read_b64_tr_b16 v[70:71], v18 offset:22528
  s_add_u32 m0, s44, 57344
  s_add_u32 s7, s45, 1507328
  buffer_load_dwordx4 v12, s[8:11], s7 offen lds
  ds_read_b64_tr_b16 v[72:73], v19 offset:20480
  v_mfma_f32_16x16x32_bf16 v[40:43], v[56:59], v[92:95], v[40:43]
  ds_read_b64_tr_b16 v[74:75], v19 offset:22528
  s_add_u32 s48, s46, 47104
  buffer_load_dwordx4 v[132:135], v13, s[12:15], s48 offen
  s_waitcnt lgkmcnt(0)
  v_mfma_f32_16x16x32_bf16 v[28:31], v[60:63], v[96:99], v[28:31]
  ds_read_b64_tr_b16 v[44:45], v16 offset:24576
  ds_read_b64_tr_b16 v[46:47], v16 offset:26624
  ds_read_b64_tr_b16 v[48:49], v17 offset:24576
  v_mfma_f32_16x16x32_bf16 v[32:35], v[64:67], v[96:99], v[32:35]
  s_add_u32 m0, s44, 61440
  s_add_u32 s7, s45, 1540096
  buffer_load_dwordx4 v12, s[8:11], s7 offen lds
  ds_read_b64_tr_b16 v[50:51], v17 offset:26624
  v_mfma_f32_16x16x32_bf16 v[36:39], v[68:71], v[96:99], v[36:39]
  ds_read_b64_tr_b16 v[52:53], v18 offset:24576
  ds_read_b64_tr_b16 v[54:55], v18 offset:26624
  s_add_u32 s48, s46, 48128
  buffer_load_dwordx4 v[136:139], v13, s[12:15], s48 offen
  v_mfma_f32_16x16x32_bf16 v[40:43], v[72:75], v[96:99], v[40:43]
  ds_read_b64_tr_b16 v[56:57], v19 offset:24576
  ds_read_b64_tr_b16 v[58:59], v19 offset:26624
  s_waitcnt lgkmcnt(0)
  v_mfma_f32_16x16x32_bf16 v[28:31], v[44:47], v[100:103], v[28:31]
  ds_read_b64_tr_b16 v[60:61], v16 offset:28672
  ds_read_b64_tr_b16 v[62:63], v16 offset:30720
  v_mfma_f32_16x16x32_bf16 v[32:35], v[48:51], v[100:103], v[32:35]
  ds_read_b64_tr_b16 v[64:65], v17 offset:28672
  ds_read_b64_tr_b16 v[66:67], v17 offset:30720
  v_mfma_f32_16x16x32_bf16 v[36:39], v[52:55], v[100:103], v[36:39]
  ds_read_b64_tr_b16 v[68:69], v18 offset:28672
  ds_read_b64_tr_b16 v[70:71], v18 offset:30720
  v_mfma_f32_16x16x32_bf16 v[40:43], v[56:59], v[100:103], v[40:43]
  ds_read_b64_tr_b16 v[72:73], v19 offset:28672
  ds_read_b64_tr_b16 v[74:75], v19 offset:30720
  s_waitcnt vmcnt(8)
  s_barrier
  s_waitcnt lgkmcnt(0)
  v_mfma_f32_16x16x32_bf16 v[28:31], v[60:63], v[104:107], v[28:31]
  ds_read_b64_tr_b16 v[44:45], v16 offset:32768
  ds_read_b64_tr_b16 v[46:47], v16 offset:34816
  ds_read_b64_tr_b16 v[48:49], v17 offset:32768
  v_mfma_f32_16x16x32_bf16 v[32:35], v[64:67], v[104:107], v[32:35]
  s_add_u32 m0, s44, 0
  s_add_u32 s7, s45, 1572864
  buffer_load_dwordx4 v12, s[8:11], s7 offen lds
  ds_read_b64_tr_b16 v[50:51], v17 offset:34816
  ds_read_b64_tr_b16 v[52:53], v18 offset:32768
  v_mfma_f32_16x16x32_bf16 v[36:39], v[68:71], v[104:107], v[36:39]
  ds_read_b64_tr_b16 v[54:55], v18 offset:34816
  s_add_u32 s48, s46, 49152
  buffer_load_dwordx4 v[76:79], v13, s[12:15], s48 offen
  ds_read_b64_tr_b16 v[56:57], v19 offset:32768
  v_mfma_f32_16x16x32_bf16 v[40:43], v[72:75], v[104:107], v[40:43]
  ds_read_b64_tr_b16 v[58:59], v19 offset:34816
  s_add_u32 m0, s44, 4096
  s_add_u32 s7, s45, 1605632
  buffer_load_dwordx4 v12, s[8:11], s7 offen lds
  s_waitcnt lgkmcnt(0)
  v_mfma_f32_16x16x32_bf16 v[28:31], v[44:47], v[108:111], v[28:31]
  ds_read_b64_tr_b16 v[60:61], v16 offset:36864
  ds_read_b64_tr_b16 v[62:63], v16 offset:38912
  ds_read_b64_tr_b16 v[64:65], v17 offset:36864
  v_mfma_f32_16x16x32_bf16 v[32:35], v[48:51], v[108:111], v[32:35]
  s_add_u32 s48, s46, 50176
  buffer_load_dwordx4 v[80:83], v13, s[12:15], s48 offen
  ds_read_b64_tr_b16 v[66:67], v17 offset:38912
  ds_read_b64_tr_b16 v[68:69], v18 offset:36864
  v_mfma_f32_16x16x32_bf16 v[36:39], v[52:55], v[108:111], v[36:39]
  ds_read_b64_tr_b16 v[70:71], v18 offset:38912
  s_add_u32 m0, s44, 8192
  s_add_u32 s7, s45, 1638400
  buffer_load_dwordx4 v12, s[8:11], s7 offen lds
  ds_read_b64_tr_b16 v[72:73], v19 offset:36864
  v_mfma_f32_16x16x32_bf16 v[40:43], v[56:59], v[108:111], v[40:43]
  ds_read_b64_tr_b16 v[74:75], v19 offset:38912
  s_add_u32 s48, s46, 51200
  buffer_load_dwordx4 v[84:87], v13, s[12:15], s48 offen
  s_waitcnt lgkmcnt(0)
  v_mfma_f32_16x16x32_bf16 v[28:31], v[60:63], v[112:115], v[28:31]
  ds_read_b64_tr_b16 v[44:45], v16 offset:40960
  ds_read_b64_tr_b16 v[46:47], v16 offset:43008
  ds_read_b64_tr_b16 v[48:49], v17 offset:40960
  v_mfma_f32_16x16x32_bf16 v[32:35], v[64:67], v[112:115], v[32:35]
  s_add_u32 m0, s44, 12288
  s_add_u32 s7, s45, 1671168
  buffer_load_dwordx4 v12, s[8:11], s7 offen lds
  ds_read_b64_tr_b16 v[50:51], v17 offset:43008
  v_mfma_f32_16x16x32_bf16 v[36:39], v[68:71], v[112:115], v[36:39]
  ds_read_b64_tr_b16 v[52:53], v18 offset:40960
  ds_read_b64_tr_b16 v[54:55], v18 offset:43008
  s_add_u32 s48, s46, 52224
  buffer_load_dwordx4 v[88:91], v13, s[12:15], s48 offen
  v_mfma_f32_16x16x32_bf16 v[40:43], v[72:75], v[112:115], v[40:43]
  ds_read_b64_tr_b16 v[56:57], v19 offset:40960
  ds_read_b64_tr_b16 v[58:59], v19 offset:43008
  s_waitcnt lgkmcnt(0)
  v_mfma_f32_16x16x32_bf16 v[28:31], v[44:47], v[116:119], v[28:31]
  ds_read_b64_tr_b16 v[60:61], v16 offset:45056
  ds_read_b64_tr_b16 v[62:63], v16 offset:47104
  v_mfma_f32_16x16x32_bf16 v[32:35], v[48:51], v[116:119], v[32:35]
  ds_read_b64_tr_b16 v[64:65], v17 offset:45056
  ds_read_b64_tr_b16 v[66:67], v17 offset:47104
  v_mfma_f32_16x16x32_bf16 v[36:39], v[52:55], v[116:119], v[36:39]
  ds_read_b64_tr_b16 v[68:69], v18 offset:45056
  ds_read_b64_tr_b16 v[70:71], v18 offset:47104
  v_mfma_f32_16x16x32_bf16 v[40:43], v[56:59], v[116:119], v[40:43]
  ds_read_b64_tr_b16 v[72:73], v19 offset:45056
  ds_read_b64_tr_b16 v[74:75], v19 offset:47104
  s_waitcnt vmcnt(8)
  s_barrier
  s_waitcnt lgkmcnt(0)
  v_mfma_f32_16x16x32_bf16 v[28:31], v[60:63], v[120:123], v[28:31]
  ds_read_b64_tr_b16 v[44:45], v16 offset:49152
  ds_read_b64_tr_b16 v[46:47], v16 offset:51200
  ds_read_b64_tr_b16 v[48:49], v17 offset:49152
  v_mfma_f32_16x16x32_bf16 v[32:35], v[64:67], v[120:123], v[32:35]
  s_add_u32 m0, s44, 16384
  s_add_u32 s7, s45, 1703936
  buffer_load_dwordx4 v12, s[8:11], s7 offen lds
  ds_read_b64_tr_b16 v[50:51], v17 offset:51200
  ds_read_b64_tr_b16 v[52:53], v18 offset:49152
  v_mfma_f32_16x16x32_bf16 v[36:39], v[68:71], v[120:123], v[36:39]
  ds_read_b64_tr_b16 v[54:55], v18 offset:51200
  s_add_u32 s48, s46, 53248
  buffer_load_dwordx4 v[92:95], v13, s[12:15], s48 offen
  ds_read_b64_tr_b16 v[56:57], v19 offset:49152
  v_mfma_f32_16x16x32_bf16 v[40:43], v[72:75], v[120:123], v[40:43]
  ds_read_b64_tr_b16 v[58:59], v19 offset:51200
  s_add_u32 m0, s44, 20480
  s_add_u32 s7, s45, 1736704
  buffer_load_dwordx4 v12, s[8:11], s7 offen lds
  s_waitcnt lgkmcnt(0)
  v_mfma_f32_16x16x32_bf16 v[28:31], v[44:47], v[124:127], v[28:31]
  ds_read_b64_tr_b16 v[60:61], v16 offset:53248
  ds_read_b64_tr_b16 v[62:63], v16 offset:55296
  ds_read_b64_tr_b16 v[64:65], v17 offset:53248
  v_mfma_f32_16x16x32_bf16 v[32:35], v[48:51], v[124:127], v[32:35]
  s_add_u32 s48, s46, 54272
  buffer_load_dwordx4 v[96:99], v13, s[12:15], s48 offen
  ds_read_b64_tr_b16 v[66:67], v17 offset:55296
  ds_read_b64_tr_b16 v[68:69], v18 offset:53248
  v_mfma_f32_16x16x32_bf16 v[36:39], v[52:55], v[124:127], v[36:39]
  ds_read_b64_tr_b16 v[70:71], v18 offset:55296
  s_add_u32 m0, s44, 24576
  s_add_u32 s7, s45, 1769472
  buffer_load_dwordx4 v12, s[8:11], s7 offen lds
  ds_read_b64_tr_b16 v[72:73], v19 offset:53248
  v_mfma_f32_16x16x32_bf16 v[40:43], v[56:59], v[124:127], v[40:43]
  ds_read_b64_tr_b16 v[74:75], v19 offset:55296
  s_add_u32 s48, s46, 55296
  buffer_load_dwordx4 v[100:103], v13, s[12:15], s48 offen
  s_waitcnt lgkmcnt(0)
  v_mfma_f32_16x16x32_bf16 v[28:31], v[60:63], v[128:131], v[28:31]
  ds_read_b64_tr_b16 v[44:45], v16 offset:57344
  ds_read_b64_tr_b16 v[46:47], v16 offset:59392
  ds_read_b64_tr_b16 v[48:49], v17 offset:57344
  v_mfma_f32_16x16x32_bf16 v[32:35], v[64:67], v[128:131], v[32:35]
  s_add_u32 m0, s44, 28672
  s_add_u32 s7, s45, 1802240
  buffer_load_dwordx4 v12, s[8:11], s7 offen lds
  ds_read_b64_tr_b16 v[50:51], v17 offset:59392
  v_mfma_f32_16x16x32_bf16 v[36:39], v[68:71], v[128:131], v[36:39]
  ds_read_b64_tr_b16 v[52:53], v18 offset:57344
  ds_read_b64_tr_b16 v[54:55], v18 offset:59392
  s_add_u32 s48, s46, 56320
  buffer_load_dwordx4 v[104:107], v13, s[12:15], s48 offen
  v_mfma_f32_16x16x32_bf16 v[40:43], v[72:75], v[128:131], v[40:43]
  ds_read_b64_tr_b16 v[56:57], v19 offset:57344
  ds_read_b64_tr_b16 v[58:59], v19 offset:59392
  s_waitcnt lgkmcnt(0)
  v_mfma_f32_16x16x32_bf16 v[28:31], v[44:47], v[132:135], v[28:31]
  ds_read_b64_tr_b16 v[60:61], v16 offset:61440
  ds_read_b64_tr_b16 v[62:63], v16 offset:63488
  v_mfma_f32_16x16x32_bf16 v[32:35], v[48:51], v[132:135], v[32:35]
  ds_read_b64_tr_b16 v[64:65], v17 offset:61440
  ds_read_b64_tr_b16 v[66:67], v17 offset:63488
  v_mfma_f32_16x16x32_bf16 v[36:39], v[52:55], v[132:135], v[36:39]
  ds_read_b64_tr_b16 v[68:69], v18 offset:61440
  ds_read_b64_tr_b16 v[70:71], v18 offset:63488
  v_mfma_f32_16x16x32_bf16 v[40:43], v[56:59], v[132:135], v[40:43]
  ds_read_b64_tr_b16 v[72:73], v19 offset:61440
  ds_read_b64_tr_b16 v[74:75], v19 offset:63488
  s_waitcnt vmcnt(8)
  s_barrier
  s_waitcnt lgkmcnt(0)
  v_mfma_f32_16x16x32_bf16 v[28:31], v[60:63], v[136:139], v[28:31]
  ds_read_b64_tr_b16 v[44:45], v16 offset:0
  ds_read_b64_tr_b16 v[46:47], v16 offset:2048
  v_mfma_f32_16x16x32_bf16 v[32:35], v[64:67], v[136:139], v[32:35]
  ds_read_b64_tr_b16 v[48:49], v17 offset:0
  ds_read_b64_tr_b16 v[50:51], v17 offset:2048
  v_mfma_f32_16x16x32_bf16 v[36:39], v[68:71], v[136:139], v[36:39]
  ds_read_b64_tr_b16 v[52:53], v18 offset:0
  ds_read_b64_tr_b16 v[54:55], v18 offset:2048
  v_mfma_f32_16x16x32_bf16 v[40:43], v[72:75], v[136:139], v[40:43]
  ds_read_b64_tr_b16 v[56:57], v19 offset:0
  ds_read_b64_tr_b16 v[58:59], v19 offset:2048
  s_waitcnt lgkmcnt(0)
  v_mfma_f32_16x16x32_bf16 v[28:31], v[44:47], v[76:79], v[28:31]
  ds_read_b64_tr_b16 v[60:61], v16 offset:4096
  ds_read_b64_tr_b16 v[62:63], v16 offset:6144
  v_mfma_f32_16x16x32_bf16 v[32:35], v[48:51], v[76:79], v[32:35]
  ds_read_b64_tr_b16 v[64:65], v17 offset:4096
  ds_read_b64_tr_b16 v[66:67], v17 offset:6144
  v_mfma_f32_16x16x32_bf16 v[36:39], v[52:55], v[76:79], v[36:39]
  ds_read_b64_tr_b16 v[68:69], v18 offset:4096
  ds_read_b64_tr_b16 v[70:71], v18 offset:6144
  v_mfma_f32_16x16x32_bf16 v[40:43], v[56:59], v[76:79], v[40:43]
  ds_read_b64_tr_b16 v[72:73], v19 offset:4096
  ds_read_b64_tr_b16 v[74:75], v19 offset:6144
  s_waitcnt lgkmcnt(0)
  v_mfma_f32_16x16x32_bf16 v[28:31], v[60:63], v[80:83], v[28:31]
  ds_read_b64_tr_b16 v[44:45], v16 offset:8192
  ds_read_b64_tr_b16 v[46:47], v16 offset:10240
  v_mfma_f32_16x16x32_bf16 v[32:35], v[64:67], v[80:83], v[32:35]
  ds_read_b64_tr_b16 v[48:49], v17 offset:8192
  ds_read_b64_tr_b16 v[50:51], v17 offset:10240
  v_mfma_f32_16x16x32_bf16 v[36:39], v[68:71], v[80:83], v[36:39]
  ds_read_b64_tr_b16 v[52:53], v18 offset:8192
  ds_read_b64_tr_b16 v[54:55], v18 offset:10240
  v_mfma_f32_16x16x32_bf16 v[40:43], v[72:75], v[80:83], v[40:43]
  ds_read_b64_tr_b16 v[56:57], v19 offset:8192
  ds_read_b64_tr_b16 v[58:59], v19 offset:10240
  s_waitcnt lgkmcnt(0)
  v_mfma_f32_16x16x32_bf16 v[28:31], v[44:47], v[84:87], v[28:31]
  ds_read_b64_tr_b16 v[60:61], v16 offset:12288
  ds_read_b64_tr_b16 v[62:63], v16 offset:14336
  v_mfma_f32_16x16x32_bf16 v[32:35], v[48:51], v[84:87], v[32:35]
  ds_read_b64_tr_b16 v[64:65], v17 offset:12288
  ds_read_b64_tr_b16 v[66:67], v17 offset:14336
  v_mfma_f32_16x16x32_bf16 v[36:39], v[52:55], v[84:87], v[36:39]
  ds_read_b64_tr_b16 v[68:69], v18 offset:12288
  ds_read_b64_tr_b16 v[70:71], v18 offset:14336
  v_mfma_f32_16x16x32_bf16 v[40:43], v[56:59], v[84:87], v[40:43]
  ds_read_b64_tr_b16 v[72:73], v19 offset:12288
  ds_read_b64_tr_b16 v[74:75], v19 offset:14336
  s_waitcnt vmcnt(0)
  s_barrier
  s_waitcnt lgkmcnt(0)
  v_mfma_f32_16x16x32_bf16 v[28:31], v[60:63], v[88:91], v[28:31]
  ds_read_b64_tr_b16 v[44:45], v16 offset:16384
  ds_read_b64_tr_b16 v[46:47], v16 offset:18432
  v_mfma_f32_16x16x32_bf16 v[32:35], v[64:67], v[88:91], v[32:35]
  ds_read_b64_tr_b16 v[48:49], v17 offset:16384
  ds_read_b64_tr_b16 v[50:51], v17 offset:18432
  v_mfma_f32_16x16x32_bf16 v[36:39], v[68:71], v[88:91], v[36:39]
  ds_read_b64_tr_b16 v[52:53], v18 offset:16384
  ds_read_b64_tr_b16 v[54:55], v18 offset:18432
  v_mfma_f32_16x16x32_bf16 v[40:43], v[72:75], v[88:91], v[40:43]
  ds_read_b64_tr_b16 v[56:57], v19 offset:16384
  ds_read_b64_tr_b16 v[58:59], v19 offset:18432
  s_waitcnt lgkmcnt(0)
  v_mfma_f32_16x16x32_bf16 v[28:31], v[44:47], v[92:95], v[28:31]
  ds_read_b64_tr_b16 v[60:61], v16 offset:20480
  ds_read_b64_tr_b16 v[62:63], v16 offset:22528
  v_mfma_f32_16x16x32_bf16 v[32:35], v[48:51], v[92:95], v[32:35]
  ds_read_b64_tr_b16 v[64:65], v17 offset:20480
  ds_read_b64_tr_b16 v[66:67], v17 offset:22528
  v_mfma_f32_16x16x32_bf16 v[36:39], v[52:55], v[92:95], v[36:39]
  ds_read_b64_tr_b16 v[68:69], v18 offset:20480
  ds_read_b64_tr_b16 v[70:71], v18 offset:22528
  v_mfma_f32_16x16x32_bf16 v[40:43], v[56:59], v[92:95], v[40:43]
  ds_read_b64_tr_b16 v[72:73], v19 offset:20480
  ds_read_b64_tr_b16 v[74:75], v19 offset:22528
  s_waitcnt lgkmcnt(0)
  v_mfma_f32_16x16x32_bf16 v[28:31], v[60:63], v[96:99], v[28:31]
  ds_read_b64_tr_b16 v[44:45], v16 offset:24576
  ds_read_b64_tr_b16 v[46:47], v16 offset:26624
  v_mfma_f32_16x16x32_bf16 v[32:35], v[64:67], v[96:99], v[32:35]
  ds_read_b64_tr_b16 v[48:49], v17 offset:24576
  ds_read_b64_tr_b16 v[50:51], v17 offset:26624
  v_mfma_f32_16x16x32_bf16 v[36:39], v[68:71], v[96:99], v[36:39]
  ds_read_b64_tr_b16 v[52:53], v18 offset:24576
  ds_read_b64_tr_b16 v[54:55], v18 offset:26624
  v_mfma_f32_16x16x32_bf16 v[40:43], v[72:75], v[96:99], v[40:43]
  ds_read_b64_tr_b16 v[56:57], v19 offset:24576
  ds_read_b64_tr_b16 v[58:59], v19 offset:26624
  s_waitcnt lgkmcnt(0)
  v_mfma_f32_16x16x32_bf16 v[28:31], v[44:47], v[100:103], v[28:31]
  ds_read_b64_tr_b16 v[60:61], v16 offset:28672
  ds_read_b64_tr_b16 v[62:63], v16 offset:30720
  v_mfma_f32_16x16x32_bf16 v[32:35], v[48:51], v[100:103], v[32:35]
  ds_read_b64_tr_b16 v[64:65], v17 offset:28672
  ds_read_b64_tr_b16 v[66:67], v17 offset:30720
  v_mfma_f32_16x16x32_bf16 v[36:39], v[52:55], v[100:103], v[36:39]
  ds_read_b64_tr_b16 v[68:69], v18 offset:28672
  ds_read_b64_tr_b16 v[70:71], v18 offset:30720
  v_mfma_f32_16x16x32_bf16 v[40:43], v[56:59], v[100:103], v[40:43]
  ds_read_b64_tr_b16 v[72:73], v19 offset:28672
  ds_read_b64_tr_b16 v[74:75], v19 offset:30720
  s_waitcnt lgkmcnt(0)
  v_mfma_f32_16x16x32_bf16 v[28:31], v[60:63], v[104:107], v[28:31]
  v_mfma_f32_16x16x32_bf16 v[32:35], v[64:67], v[104:107], v[32:35]
  v_mfma_f32_16x16x32_bf16 v[36:39], v[68:71], v[104:107], v[36:39]
  v_mfma_f32_16x16x32_bf16 v[40:43], v[72:75], v[104:107], v[40:43]
  s_nop 7
  s_nop 1
  v_lshlrev_b32 v4, 10, v3
  v_lshl_add_u32 v4, v2, 3, v4
  s_lshl_b32 s6, s3, 2
  s_add_u32 s6, s6, s5
  s_lshl_b32 s6, s6, 14
  s_lshl_b32 s7, s4, 7
  s_add_u32 s6, s6, s7
  v_cvt_pk_bf16_f32 v6, v28, v29
  v_lshlrev_b32 v28, 16, v6
  v_and_b32 v29, 0xffff0000, v6
  v_lshlrev_b32 v6, 16, v20
  v_and_b32 v7, 0xffff0000, v20
  v_add_f32 v28, v28, v6
  v_add_f32 v29, v29, v7
  v_cvt_pk_bf16_f32 v28, v28, v29
  v_cvt_pk_bf16_f32 v6, v30, v31
  v_lshlrev_b32 v30, 16, v6
  v_and_b32 v31, 0xffff0000, v6
  v_lshlrev_b32 v6, 16, v21
  v_and_b32 v7, 0xffff0000, v21
  v_add_f32 v30, v30, v6
  v_add_f32 v31, v31, v7
  v_cvt_pk_bf16_f32 v29, v30, v31
  buffer_store_dwordx2 v[28:29], v4, s[16:19], s6 offen offset:0
  v_cvt_pk_bf16_f32 v6, v32, v33
  v_lshlrev_b32 v32, 16, v6
  v_and_b32 v33, 0xffff0000, v6
  v_lshlrev_b32 v6, 16, v22
  v_and_b32 v7, 0xffff0000, v22
  v_add_f32 v32, v32, v6
  v_add_f32 v33, v33, v7
  v_cvt_pk_bf16_f32 v32, v32, v33
  v_cvt_pk_bf16_f32 v6, v34, v35
  v_lshlrev_b32 v34, 16, v6
  v_and_b32 v35, 0xffff0000, v6
  v_lshlrev_b32 v6, 16, v23
  v_and_b32 v7, 0xffff0000, v23
  v_add_f32 v34, v34, v6
  v_add_f32 v35, v35, v7
  v_cvt_pk_bf16_f32 v33, v34, v35
  buffer_store_dwordx2 v[32:33], v4, s[16:19], s6 offen offset:32
  v_cvt_pk_bf16_f32 v6, v36, v37
  v_lshlrev_b32 v36, 16, v6
  v_and_b32 v37, 0xffff0000, v6
  v_lshlrev_b32 v6, 16, v24
  v_and_b32 v7, 0xffff0000, v24
  v_add_f32 v36, v36, v6
  v_add_f32 v37, v37, v7
  v_cvt_pk_bf16_f32 v36, v36, v37
  v_cvt_pk_bf16_f32 v6, v38, v39
  v_lshlrev_b32 v38, 16, v6
  v_and_b32 v39, 0xffff0000, v6
  v_lshlrev_b32 v6, 16, v25
  v_and_b32 v7, 0xffff0000, v25
  v_add_f32 v38, v38, v6
  v_add_f32 v39, v39, v7
  v_cvt_pk_bf16_f32 v37, v38, v39
  buffer_store_dwordx2 v[36:37], v4, s[16:19], s6 offen offset:64
  v_cvt_pk_bf16_f32 v6, v40, v41
  v_lshlrev_b32 v40, 16, v6
  v_and_b32 v41, 0xffff0000, v6
  v_lshlrev_b32 v6, 16, v26
  v_and_b32 v7, 0xffff0000, v26
  v_add_f32 v40, v40, v6
  v_add_f32 v41, v41, v7
  v_cvt_pk_bf16_f32 v40, v40, v41
  v_cvt_pk_bf16_f32 v6, v42, v43
  v_lshlrev_b32 v42, 16, v6
  v_and_b32 v43, 0xffff0000, v6
  v_lshlrev_b32 v6, 16, v27
  v_and_b32 v7, 0xffff0000, v27
  v_add_f32 v42, v42, v6
  v_add_f32 v43, v43, v7
  v_cvt_pk_bf16_f32 v41, v42, v43
  buffer_store_dwordx2 v[40:41], v4, s[16:19], s6 offen offset:96
k4_kernel_end:
  s_endpgm
.section .rodata,"a"
.p2align 6

.amdhsa_kernel k1_kernel
  .amdhsa_next_free_vgpr 256
  .amdhsa_next_free_sgpr 102
  .amdhsa_accum_offset 256
  .amdhsa_group_segment_fixed_size 0
  .amdhsa_kernarg_size 72
  .amdhsa_user_sgpr_count 2
  .amdhsa_user_sgpr_kernarg_segment_ptr 1
  .amdhsa_system_sgpr_workgroup_id_x 1
.end_amdhsa_kernel

.p2align 6

.amdhsa_kernel k2_kernel
  .amdhsa_next_free_vgpr 256
  .amdhsa_next_free_sgpr 102
  .amdhsa_accum_offset 256
  .amdhsa_group_segment_fixed_size 0
  .amdhsa_kernarg_size 72
  .amdhsa_user_sgpr_count 2
  .amdhsa_user_sgpr_kernarg_segment_ptr 1
  .amdhsa_system_sgpr_workgroup_id_x 1
.end_amdhsa_kernel

.p2align 6

.amdhsa_kernel k3_kernel
  .amdhsa_next_free_vgpr 176
  .amdhsa_next_free_sgpr 102
  .amdhsa_accum_offset 176
  .amdhsa_group_segment_fixed_size 0
  .amdhsa_kernarg_size 72
  .amdhsa_user_sgpr_count 2
  .amdhsa_user_sgpr_kernarg_segment_ptr 1
  .amdhsa_system_sgpr_workgroup_id_x 1
.end_amdhsa_kernel

.p2align 6

.amdhsa_kernel k4_kernel
  .amdhsa_next_free_vgpr 160
  .amdhsa_next_free_sgpr 102
  .amdhsa_accum_offset 160
  .amdhsa_group_segment_fixed_size 0
  .amdhsa_kernarg_size 72
  .amdhsa_user_sgpr_count 2
  .amdhsa_user_sgpr_kernarg_segment_ptr 1
  .amdhsa_system_sgpr_workgroup_id_x 1
.end_amdhsa_kernel
```
